```python
import torch

def _softmax(x, axis=-1):
    return torch.softmax(x, dim=axis)
def _gelu(x):
    return torch.nn.functional.gelu(x, approximate="tanh")
def _silu(x):
    return torch.nn.functional.silu(x)
def _sigmoid(x):
    return torch.sigmoid(x)
def _layernorm(x, axis=-1, eps=1e-5):
    m = x.mean(dim=axis, keepdim=True)
    v = x.var(dim=axis, keepdim=True, unbiased=False)
    return (x - m) / torch.sqrt(v + eps)
def _scatter_add(tgt, idx, src, axis=0):
    return tgt.clone().index_add_(axis, idx, src)
def _segment_sum(src, seg, n):
    out = torch.zeros((n,) + src.shape[1:], dtype=src.dtype)
    return out.index_add_(0, seg, src)
def _pad(x, pw):
    flat = tuple(v for pair in reversed(pw) for v in pair)
    return torch.nn.functional.pad(x, flat)

kernel_name = 'gated_mix__linear_attn_block__sliding_local_dilated__prompt'

def setup_inputs():

    _w = (lambda a: (lambda t: t.to(torch.bfloat16) if t.is_floating_point() else t)(torch.as_tensor(a)))
    def _A_setup():
        B, S, D = 1, 2048, 512
        return {
            "x": _w((lambda *s: torch.randn(*s, dtype=torch.bfloat16) * 0.05)(B, S, D)),
            "wqkv": _w((lambda *s: torch.randn(*s, dtype=torch.bfloat16) * 1.6)(D, 3 * D)),
            "wo": _w((lambda *s: torch.randn(*s, dtype=torch.bfloat16) * 0.4)(D, D)),
        }
    _A_in = _A_setup()

    def _B_setup():
        B, S, D = 1, 2048, 512
        return {
            "x": _w((lambda *s: torch.randn(*s, dtype=torch.bfloat16) * 0.05)(B, S, D)),
            "wqkv": _w((lambda *s: torch.randn(*s, dtype=torch.bfloat16) * 0.8)(D, 3 * D)),
            "wo": _w((lambda *s: torch.randn(*s, dtype=torch.bfloat16) * 0.05)(D, D)),
        }
    _B_in = _B_setup()

    return {
        "A_x": _A_in["x"],
        "A_wqkv": _A_in["wqkv"],
        "A_wo": _A_in["wo"],
        "B_x": _B_in["x"],
        "B_wqkv": _B_in["wqkv"],
        "B_wo": _B_in["wo"],
        "gate_w": _w((lambda *s: torch.randn(*s, dtype=torch.bfloat16) * 0.05)(512) * 16.0),
    }

def reference(A_x, A_wqkv, A_wo, B_x, B_wqkv, B_wo, gate_w):
    def _A_ref(x, wqkv, wo):
        B, S, D = x.shape
        H = 32; Dh = D // H
        qkv = (lambda x, *d: x.permute(*d))((x @ wqkv).reshape(B, S, 3, H, Dh), 2, 0, 3, 1, 4)
        q, k, v = qkv[0], qkv[1], qkv[2]
        phi = lambda t: torch.where(t > 0, t + 1, torch.exp(t)) + 1e-6
        pq, pk = phi(q), phi(k)
        kv = torch.einsum("bhsd,bhse->bhde", pk, v)
        z = torch.einsum("bhsd->bhd", pk)
        num = torch.einsum("bhqd,bhde->bhqe", pq, kv)
        den = torch.einsum("bhqd,bhd->bhq", pq, z)[..., None] + 1e-6
        o = num / den
        return (lambda x, *d: x.permute(*d))(o, 0, 2, 1, 3).reshape(B, S, D) @ wo

    def _B_ref(x, wqkv, wo):
        B, S, D = x.shape
        H = 32; Dh = D // H
        W, dil = 8, 2
        qkv = (lambda x, *d: x.permute(*d))((x @ wqkv).reshape(B, S, 3, H, Dh), 2, 0, 3, 1, 4)
        q, k, v = qkv[0], qkv[1], qkv[2]
        scale = Dh ** -0.5
        pos = torch.arange(S)
        off = torch.arange(W) * dil
        idx = pos[:, None] - off[None, :]
        mask = idx >= 0
        idx_c = torch.where(mask, idx, 0).reshape(-1)
        kg = k[:, :, idx_c, :].reshape(B, H, S, W, Dh)
        vg = v[:, :, idx_c, :].reshape(B, H, S, W, Dh)
        logits = torch.einsum("bhsd,bhswd->bhsw", q, kg) * scale
        logits = torch.where(mask[None, None, :, :], logits, -1e9)
        attn = _softmax(logits, axis=-1)
        o = torch.einsum("bhsw,bhswd->bhsd", attn, vg)
        return (lambda x, *d: x.permute(*d))(o, 0, 2, 1, 3).reshape(B, S, D) @ wo

    x = A_x
    g = _sigmoid((x * gate_w).sum(-1, keepdims=True))
    a = _A_ref(x, A_wqkv, A_wo)
    b = _B_ref(x, B_wqkv, B_wo)
    return g * a + (1 - g) * b
```

```asm
; @launch grid=(256,1,1) block=(512,1,1) lds=163840
.amdgcn_target "amdgcn-amd-amdhsa--gfx950"
.text
.globl gated_mix__linear_attn_block__sliding_local_dilated__prompt_kernel
.p2align 8
.type gated_mix__linear_attn_block__sliding_local_dilated__prompt_kernel,@function
gated_mix__linear_attn_block__sliding_local_dilated__prompt_kernel:
    s_cmp_ge_u32 s2, 256
    s_cbranch_scc1 L_END
    s_load_dwordx4 s[4:7], s[0:1], 0
    s_load_dwordx2 s[54:55], s[0:1], 32
    s_load_dwordx2 s[20:21], s[0:1], 48
    s_load_dwordx4 s[60:63], s[0:1], 56
    s_load_dwordx2 s[56:57], s[0:1], 72
    s_load_dwordx2 s[82:83], s[0:1], 16
    s_load_dwordx2 s[84:85], s[0:1], 40
    v_lshrrev_b32 v24, 6, v0
    v_and_b32 v1, 63, v0
    v_readfirstlane_b32 s24, v24
    s_and_b32 s34, s2, 7
    s_lshr_b32 s35, s2, 3
    s_and_b32 s25, s34, 1
    s_lshl_b32 s25, s25, 3
    s_and_b32 s36, s35, 7
    s_add_u32 s25, s25, s36
    s_lshr_b32 s37, s35, 3
    s_lshl_b32 s27, s37, 1
    s_add_u32 s27, s27, s36
    s_and_b32 s27, s27, 4
    s_lshr_b32 s34, s34, 1
    s_lshl_b32 s34, s34, 2
    s_add_u32 s34, s34, s37
    s_lshr_b32 s41, s34, 3
    s_xor_b32 s41, s41, 0
    s_and_b32 s26, s34, 7
    s_and_b32 s38, s24, 3
    s_lshr_b32 s39, s24, 2
    s_lshl_b32 s28, s25, 17
    s_lshl_b32 s34, s24, 14
    s_add_u32 s28, s28, s34
    s_mul_i32 s42, s24, 24576
    s_lshl_b32 s34, s26, 7
    s_add_u32 s42, s42, s34
    s_lshl_b32 s31, s24, 11
    s_add_u32 s32, s31, 17408
    s_and_b32 s35, s24, 1
    s_lshl_b32 s35, s35, 2
    v_lshrrev_b32 v24, 3, v1
    v_lshrrev_b32 v25, 4, v1
    v_and_b32 v26, 7, v1
    v_xor_b32 v27, v26, v25
    v_lshlrev_b32 v27, 4, v27
    v_lshl_add_u32 v2, v24, 10, v27
    v_add_u32 v2, s28, v2
    v_xor_b32 v3, 64, v2
    v_add_u32 v3, 7168, v3
    v_and_b32 v25, 1, v25
    v_lshlrev_b32 v25, 1, v25
    v_or_b32 v25, s35, v25
    v_xor_b32 v27, v26, v25
    v_lshlrev_b32 v27, 4, v27
    v_mul_u32_u24 v4, 3072, v24
    v_add_u32 v4, v4, v27
    v_add_u32 v4, s42, v4
    s_add_u32 s34, s27, 0
    s_and_b32 s34, s34, 7
    s_lshl_b32 s66, s34, 7
    s_mul_i32 s74, s34, 196608
    s_cmp_eq_u32 s41, 0
    s_waitcnt lgkmcnt(0)
    s_cselect_b32 s12, s6, s54
    s_cselect_b32 s13, s7, s55
    s_mov_b32 s14, 1572864
    s_mov_b32 s15, 0x20000
    s_mov_b32 s8, s4
    s_mov_b32 s9, s5
    s_mov_b32 s10, 2097152
    s_mov_b32 s11, 0x20000
    s_cmp_eq_u32 s41, 1
    s_cbranch_scc1 L_B
    s_add_u32 m0, s31, 0
    s_nop 0
    buffer_load_dwordx4 v2, s[8:11], s66 offen lds
    buffer_load_dwordx4 v3, s[8:11], s66 offen offset:1024 lds
    s_add_u32 m0, s32, 0
    s_nop 0
    buffer_load_dwordx4 v4, s[12:15], s74 offen offset:1024 lds
    buffer_load_dwordx4 v4, s[12:15], s74 offen offset:2048 lds
    s_add_u32 s67, s66, 128
    s_and_b32 s67, s67, 1023
    s_mul_i32 s75, s67, 1536
    s_barrier
    s_add_u32 m0, s31, 34816
    s_nop 0
    buffer_load_dwordx4 v2, s[8:11], s67 offen lds
    buffer_load_dwordx4 v3, s[8:11], s67 offen offset:1024 lds
    s_add_u32 m0, s32, 34816
    s_nop 0
    buffer_load_dwordx4 v4, s[12:15], s75 offen offset:1024 lds
    buffer_load_dwordx4 v4, s[12:15], s75 offen offset:2048 lds
    v_and_b32 v24, 15, v1
    v_lshrrev_b32 v25, 4, v1
    v_lshrrev_b32 v26, 1, v24
    v_xor_b32 v26, v26, v25
    v_lshlrev_b32 v26, 4, v26
    v_lshl_add_u32 v26, v24, 7, v26
    s_lshl_b32 s34, s38, 12
    v_add_u32 v6, s34, v26
    v_xor_b32 v7, 64, v6
    v_add_u32 v8, 69632, v6
    v_add_u32 v9, 69632, v7
    v_and_b32 v24, 15, v1
    v_lshrrev_b32 v25, 4, v1
    v_lshrrev_b32 v26, 2, v24
    v_lshrrev_b32 v27, 1, v26
    v_and_b32 v20, 1, v25
    v_lshl_or_b32 v27, v20, 1, v27
    s_lshl_b32 s34, s39, 1
    v_xor_b32 v27, s34, v27
    v_lshlrev_b32 v27, 5, v27
    v_lshl_add_u32 v27, v26, 7, v27
    v_lshl_add_u32 v27, v25, 11, v27
    v_and_b32 v20, 3, v1
    v_lshl_add_u32 v10, v20, 3, v27
    v_xor_b32 v11, 32, v10
    v_add_u32 v12, 69632, v10
    v_add_u32 v13, 69632, v11
    s_add_u32 s68, s67, 128
    s_and_b32 s68, s68, 1023
    s_mul_i32 s76, s68, 1536
    s_add_u32 s69, s68, 128
    s_and_b32 s69, s69, 1023
    s_mul_i32 s77, s69, 1536
    s_waitcnt vmcnt(4)
    s_barrier
    ds_read_b128 a[0:3], v6 offset:0
    ds_read_b64_tr_b16 v[28:29], v10 offset:18432
    ds_read_b64_tr_b16 v[30:31], v10 offset:18944
    ds_read_b128 a[4:7], v6 offset:2048
    ds_read_b64_tr_b16 v[32:33], v11 offset:18432
    ds_read_b64_tr_b16 v[34:35], v11 offset:18944
    ds_read_b64_tr_b16 v[36:37], v10 offset:19456
    ds_read_b64_tr_b16 v[38:39], v10 offset:19968
    ds_read_b64_tr_b16 v[40:41], v11 offset:19456
    ds_read_b64_tr_b16 v[42:43], v11 offset:19968
    s_waitcnt lgkmcnt(0)
    v_mfma_f32_16x16x32_bf16 v[76:79], a[0:3], v[28:31], 0
    ds_read_b128 a[8:11], v7 offset:0
    ds_read_b64_tr_b16 v[44:45], v10 offset:26624
    s_add_u32 s70, s69, 128
    v_mfma_f32_16x16x32_bf16 v[84:87], a[4:7], v[28:31], 0
    ds_read_b64_tr_b16 v[46:47], v10 offset:27136
    ds_read_b128 a[12:15], v7 offset:2048
    s_and_b32 s70, s70, 1023
    v_mfma_f32_16x16x32_bf16 v[80:83], a[0:3], v[32:35], 0
    ds_read_b64_tr_b16 v[48:49], v11 offset:26624
    ds_read_b64_tr_b16 v[50:51], v11 offset:27136
    s_mul_i32 s78, s70, 1536
    v_mfma_f32_16x16x32_bf16 v[88:91], a[4:7], v[32:35], 0
    ds_read_b64_tr_b16 v[52:53], v10 offset:27648
    ds_read_b64_tr_b16 v[54:55], v10 offset:28160
    s_add_u32 s71, s70, 128
    v_mfma_f32_16x16x32_bf16 v[92:95], a[0:3], v[36:39], 0
    ds_read_b64_tr_b16 v[56:57], v11 offset:27648
    ds_read_b64_tr_b16 v[58:59], v11 offset:28160
    s_and_b32 s71, s71, 1023
    s_mul_i32 s79, s71, 1536
    s_add_u32 s72, s71, 128
    s_and_b32 s72, s72, 1023
    v_mfma_f32_16x16x32_bf16 v[100:103], a[4:7], v[36:39], 0
    s_add_u32 m0, s31, 69632
    s_nop 0
    buffer_load_dwordx4 v2, s[8:11], s68 offen lds
    buffer_load_dwordx4 v3, s[8:11], s68 offen offset:1024 lds
    s_mul_i32 s80, s72, 1536
    s_add_u32 s73, s72, 128
    v_mfma_f32_16x16x32_bf16 v[96:99], a[0:3], v[40:43], 0
    s_add_u32 m0, s32, 69632
    s_nop 0
    buffer_load_dwordx4 v4, s[12:15], s76 offen offset:1024 lds
    buffer_load_dwordx4 v4, s[12:15], s76 offen offset:2048 lds
    s_and_b32 s73, s73, 1023
    s_mul_i32 s81, s73, 1536
    v_mfma_f32_16x16x32_bf16 v[104:107], a[4:7], v[40:43], 0
    s_add_u32 m0, s31, 104448
    s_nop 0
    buffer_load_dwordx4 v2, s[8:11], s69 offen lds
    buffer_load_dwordx4 v3, s[8:11], s69 offen offset:1024 lds
    s_mov_b32 s58, s62
    s_mov_b32 s59, s63
    s_waitcnt vmcnt(6) lgkmcnt(0)
    s_barrier
    v_mfma_f32_16x16x32_bf16 v[76:79], a[8:11], v[44:47], v[76:79]
    ds_read_b128 a[16:19], v6 offset:34816
    ds_read_b64_tr_b16 v[28:29], v10 offset:53248
    s_mov_b32 s62, 2097152
    v_mfma_f32_16x16x32_bf16 v[84:87], a[12:15], v[44:47], v[84:87]
    ds_read_b64_tr_b16 v[30:31], v10 offset:53760
    ds_read_b128 a[20:23], v6 offset:36864
    s_mov_b32 s63, 0x20000
    v_mfma_f32_16x16x32_bf16 v[80:83], a[8:11], v[48:51], v[80:83]
    ds_read_b64_tr_b16 v[32:33], v11 offset:53248
    ds_read_b64_tr_b16 v[34:35], v11 offset:53760
    s_mov_b32 s16, s56
    v_mfma_f32_16x16x32_bf16 v[88:91], a[12:15], v[48:51], v[88:91]
    ds_read_b64_tr_b16 v[36:37], v10 offset:54272
    ds_read_b64_tr_b16 v[38:39], v10 offset:54784
    s_mov_b32 s17, s57
    v_mfma_f32_16x16x32_bf16 v[92:95], a[8:11], v[52:55], v[92:95]
    ds_read_b64_tr_b16 v[40:41], v11 offset:54272
    ds_read_b64_tr_b16 v[42:43], v11 offset:54784
    s_mov_b32 s18, 268435456
    s_mov_b32 s19, 0x20000
    s_or_b32 s34, s2, s24
    s_cmp_lg_u32 s34, 0
    s_cbranch_scc1 NONCE_1001
    s_memrealtime s[44:45]
    s_waitcnt lgkmcnt(0)
    s_mul_i32 s44, s44, 0x9E3779B1
    s_or_b32 s44, s44, 1
    v_mov_b32 v24, s44
    v_mov_b32 v25, 0
    s_mov_b64 exec, 1
    global_store_dword v25, v24, s[58:59] sc1
    s_mov_b64 exec, -1
NONCE_1001:
    s_nop 0
    v_mfma_f32_16x16x32_bf16 v[100:103], a[12:15], v[52:55], v[100:103]
    s_add_u32 m0, s32, 104448
    s_nop 0
    buffer_load_dwordx4 v4, s[12:15], s77 offen offset:1024 lds
    buffer_load_dwordx4 v4, s[12:15], s77 offen offset:2048 lds
    s_mov_b32 s22, 1024
    s_mov_b32 s23, 0x20000
    v_mfma_f32_16x16x32_bf16 v[96:99], a[8:11], v[56:59], v[96:99]
    s_add_u32 m0, s31, 0
    s_nop 0
    buffer_load_dwordx4 v2, s[8:11], s70 offen lds
    buffer_load_dwordx4 v3, s[8:11], s70 offen offset:1024 lds
    s_lshl_b32 s34, s27, 3
    v_add_u32 v23, s34, v1
    v_mfma_f32_16x16x32_bf16 v[104:107], a[12:15], v[56:59], v[104:107]
    s_add_u32 m0, s32, 0
    s_nop 0
    buffer_load_dwordx4 v4, s[12:15], s78 offen offset:1024 lds
    buffer_load_dwordx4 v4, s[12:15], s78 offen offset:2048 lds
    v_and_b32 v23, 63, v23
    v_lshlrev_b32 v23, 4, v23
    s_waitcnt lgkmcnt(0)
    v_mfma_f32_16x16x32_bf16 v[76:79], a[16:19], v[28:31], v[76:79]
    ds_read_b128 a[24:27], v7 offset:34816
    ds_read_b64_tr_b16 v[44:45], v10 offset:61440
    s_mov_b32 m0, 139264
    s_nop 0
    buffer_load_dwordx4 v23, s[20:23], 0 offen lds
    v_mfma_f32_16x16x32_bf16 v[84:87], a[20:23], v[28:31], v[84:87]
    ds_read_b64_tr_b16 v[46:47], v10 offset:61952
    ds_read_b128 a[28:31], v7 offset:36864
    s_and_b32 s34, s2, 7
    v_mfma_f32_16x16x32_bf16 v[80:83], a[16:19], v[32:35], v[80:83]
    ds_read_b64_tr_b16 v[48:49], v11 offset:61440
    ds_read_b64_tr_b16 v[50:51], v11 offset:61952
    s_lshr_b32 s35, s2, 3
    v_mfma_f32_16x16x32_bf16 v[88:91], a[20:23], v[32:35], v[88:91]
    ds_read_b64_tr_b16 v[52:53], v10 offset:62464
    ds_read_b64_tr_b16 v[54:55], v10 offset:62976
    s_lshr_b32 s54, s34, 1
    v_mfma_f32_16x16x32_bf16 v[92:95], a[16:19], v[36:39], v[92:95]
    ds_read_b64_tr_b16 v[56:57], v11 offset:62464
    ds_read_b64_tr_b16 v[58:59], v11 offset:62976
    s_lshl_b32 s54, s54, 3
    s_and_b32 s36, s35, 7
    s_add_u32 s54, s54, s36
    s_lshr_b32 s37, s35, 3
    v_mfma_f32_16x16x32_bf16 v[100:103], a[20:23], v[36:39], v[100:103]
    s_and_b32 s55, s34, 1
    s_lshl_b32 s55, s55, 2
    s_add_u32 s55, s55, s37
    s_lshl_b32 s65, s24, 13
    v_mfma_f32_16x16x32_bf16 v[96:99], a[16:19], v[40:43], v[96:99]
    s_lshl_b32 s34, s55, 7
    s_add_u32 s65, s65, s34
    s_mov_b32 s20, s84
    s_mov_b32 s21, s85
    v_mfma_f32_16x16x32_bf16 v[104:107], a[20:23], v[40:43], v[104:107]
    s_mov_b32 s22, 524288
    s_mov_b32 s23, 0x20000
    s_mov_b32 s4, s82
    s_mov_b32 s5, s83
    s_waitcnt vmcnt(9) lgkmcnt(0)
    s_barrier
    v_mfma_f32_16x16x32_bf16 v[76:79], a[24:27], v[44:47], v[76:79]
    ds_read_b128 a[32:35], v8 offset:0
    ds_read_b64_tr_b16 v[28:29], v12 offset:18432
    s_mov_b32 s6, 524288
    v_mfma_f32_16x16x32_bf16 v[84:87], a[28:31], v[44:47], v[84:87]
    ds_read_b64_tr_b16 v[30:31], v12 offset:18944
    ds_read_b128 a[36:39], v8 offset:2048
    s_mov_b32 s7, 0x20000
    v_mfma_f32_16x16x32_bf16 v[80:83], a[24:27], v[48:51], v[80:83]
    ds_read_b64_tr_b16 v[32:33], v13 offset:18432
    ds_read_b64_tr_b16 v[34:35], v13 offset:18944
    s_lshl_b32 s34, s39, 3
    v_mfma_f32_16x16x32_bf16 v[88:91], a[28:31], v[48:51], v[88:91]
    ds_read_b64_tr_b16 v[36:37], v12 offset:19456
    ds_read_b64_tr_b16 v[38:39], v12 offset:19968
    s_add_u32 s34, s34, s38
    v_mfma_f32_16x16x32_bf16 v[92:95], a[24:27], v[52:55], v[92:95]
    ds_read_b64_tr_b16 v[40:41], v13 offset:19456
    ds_read_b64_tr_b16 v[42:43], v13 offset:19968
    s_lshl_b32 s35, s34, 10
    s_add_u32 s35, s35, 140288
    v_lshl_add_u32 v64, v1, 4, s35
    s_lshl_b32 s35, s34, 6
    v_mfma_f32_16x16x32_bf16 v[100:103], a[28:31], v[52:55], v[100:103]
    s_add_u32 s35, s35, 156672
    v_and_b32 v71, 15, v1
    v_lshl_add_u32 v65, v71, 2, s35
    s_and_b32 s36, s38, 1
    v_mfma_f32_16x16x32_bf16 v[96:99], a[24:27], v[56:59], v[96:99]
    s_lshl_b32 s37, s39, 1
    s_add_u32 s36, s36, s37
    s_lshl_b32 s35, s36, 12
    s_add_u32 s35, s35, 140288
    v_mfma_f32_16x16x32_bf16 v[104:107], a[28:31], v[56:59], v[104:107]
    v_lshl_add_u32 v66, v1, 4, s35
    s_lshl_b32 s35, s36, 8
    s_add_u32 s35, s35, 156672
    v_lshl_add_u32 v67, v71, 2, s35
    s_waitcnt lgkmcnt(0)
    v_mfma_f32_16x16x32_bf16 v[76:79], a[32:35], v[28:31], v[76:79]
    ds_read_b128 a[40:43], v9 offset:0
    ds_read_b64_tr_b16 v[44:45], v12 offset:26624
    s_lshl_b32 s34, s26, 4
    v_mfma_f32_16x16x32_bf16 v[84:87], a[36:39], v[28:31], v[84:87]
    ds_read_b64_tr_b16 v[46:47], v12 offset:27136
    ds_read_b128 a[44:47], v9 offset:2048
    s_add_u32 s35, s34, s25
    v_mfma_f32_16x16x32_bf16 v[80:83], a[32:35], v[32:35], v[80:83]
    ds_read_b64_tr_b16 v[48:49], v13 offset:26624
    ds_read_b64_tr_b16 v[50:51], v13 offset:27136
    s_lshl_b32 s35, s35, 2
    v_mfma_f32_16x16x32_bf16 v[88:91], a[36:39], v[32:35], v[88:91]
    ds_read_b64_tr_b16 v[52:53], v12 offset:27648
    ds_read_b64_tr_b16 v[54:55], v12 offset:28160
    s_add_u32 s35, s35, s36
    v_mfma_f32_16x16x32_bf16 v[92:95], a[32:35], v[36:39], v[92:95]
    ds_read_b64_tr_b16 v[56:57], v13 offset:27648
    ds_read_b64_tr_b16 v[58:59], v13 offset:28160
    s_lshl_b32 s35, s35, 10
    s_add_u32 s94, s35, 65536
    s_lshr_b32 s37, s38, 1
    s_lshl_b32 s35, s37, 3
    v_mfma_f32_16x16x32_bf16 v[100:103], a[36:39], v[36:39], v[100:103]
    s_add_u32 s35, s35, s34
    s_lshl_b32 s35, s35, 2
    s_add_u32 s35, s35, s36
    s_lshl_b32 s35, s35, 10
    v_mfma_f32_16x16x32_bf16 v[96:99], a[32:35], v[40:43], v[96:99]
    s_add_u32 s86, s35, 65536
    s_add_u32 s87, s86, 4096
    s_add_u32 s88, s86, 8192
    s_add_u32 s89, s86, 12288
    v_mfma_f32_16x16x32_bf16 v[104:107], a[36:39], v[40:43], v[104:107]
    s_add_u32 s90, s86, 16384
    s_add_u32 s91, s86, 20480
    s_add_u32 s92, s86, 24576
    s_add_u32 s93, s86, 28672
    s_waitcnt vmcnt(5) lgkmcnt(0)
    s_barrier
    v_mfma_f32_16x16x32_bf16 v[76:79], a[40:43], v[44:47], v[76:79]
    ds_read_b128 a[48:51], v8 offset:34816
    ds_read_b64_tr_b16 v[28:29], v12 offset:53248
    s_lshl_b32 s35, s36, 1
    v_mfma_f32_16x16x32_bf16 v[84:87], a[44:47], v[44:47], v[84:87]
    ds_read_b64_tr_b16 v[30:31], v12 offset:53760
    ds_read_b128 a[52:55], v8 offset:36864
    s_add_u32 s35, s35, s37
    v_mfma_f32_16x16x32_bf16 v[80:83], a[40:43], v[48:51], v[80:83]
    ds_read_b64_tr_b16 v[32:33], v13 offset:53248
    ds_read_b64_tr_b16 v[34:35], v13 offset:53760
    s_lshl_b32 s34, s35, 10
    v_mfma_f32_16x16x32_bf16 v[88:91], a[44:47], v[48:51], v[88:91]
    ds_read_b64_tr_b16 v[36:37], v12 offset:54272
    ds_read_b64_tr_b16 v[38:39], v12 offset:54784
    s_add_u32 s34, s34, 140288
    v_mfma_f32_16x16x32_bf16 v[92:95], a[40:43], v[52:55], v[92:95]
    ds_read_b64_tr_b16 v[40:41], v13 offset:54272
    ds_read_b64_tr_b16 v[42:43], v13 offset:54784
    v_lshl_add_u32 v68, v1, 4, s34
    s_lshl_b32 s34, s35, 6
    s_add_u32 s34, s34, 156672
    v_lshl_add_u32 v69, v71, 2, s34
    v_mfma_f32_16x16x32_bf16 v[100:103], a[44:47], v[52:55], v[100:103]
    v_mov_b32 v112, 0
    global_load_dword v22, v112, s[58:59] sc1
    s_lshl_b32 s34, s39, 12
    s_add_u32 s34, s34, 140288
    v_mfma_f32_16x16x32_bf16 v[96:99], a[40:43], v[56:59], v[96:99]
    s_add_u32 m0, s31, 34816
    s_nop 0
    buffer_load_dwordx4 v2, s[8:11], s71 offen lds
    buffer_load_dwordx4 v3, s[8:11], s71 offen offset:1024 lds
    v_lshl_add_u32 v70, v1, 4, s34
    s_lshl_b32 s34, s39, 8
    v_mfma_f32_16x16x32_bf16 v[104:107], a[44:47], v[56:59], v[104:107]
    s_add_u32 s34, s34, 156672
    v_lshrrev_b32 v71, 4, v1
    v_lshl_add_u32 v71, v71, 4, s34
    v_mov_b32 v20, 0x3fb8aa3b
    s_waitcnt lgkmcnt(0)
    v_mfma_f32_16x16x32_bf16 v[76:79], a[48:51], v[28:31], v[76:79]
    ds_read_b128 a[56:59], v9 offset:34816
    ds_read_b64_tr_b16 v[44:45], v12 offset:61440
    v_mov_b32 v21, 0x358637bd
    v_mfma_f32_16x16x32_bf16 v[84:87], a[52:55], v[28:31], v[84:87]
    ds_read_b64_tr_b16 v[46:47], v12 offset:61952
    ds_read_b128 a[60:63], v9 offset:36864
    v_lshlrev_b32 v72, 4, v1
    v_mfma_f32_16x16x32_bf16 v[80:83], a[48:51], v[32:35], v[80:83]
    ds_read_b64_tr_b16 v[48:49], v13 offset:61440
    ds_read_b64_tr_b16 v[50:51], v13 offset:61952
    v_mov_b32 v60, 0x3f803f80
    v_mfma_f32_16x16x32_bf16 v[88:91], a[52:55], v[32:35], v[88:91]
    ds_read_b64_tr_b16 v[52:53], v12 offset:62464
    ds_read_b64_tr_b16 v[54:55], v12 offset:62976
    v_mov_b32 v61, 0x3f803f80
    v_mfma_f32_16x16x32_bf16 v[92:95], a[48:51], v[36:39], v[92:95]
    ds_read_b64_tr_b16 v[56:57], v13 offset:62464
    ds_read_b64_tr_b16 v[58:59], v13 offset:62976
    v_mov_b32 v62, 0x3f803f80
    v_mov_b32 v63, 0x3f803f80
    v_mov_b32 v113, 163776
    v_mov_b32 v114, 0
    v_mov_b32 v115, 0
    ds_write_b64 v113, v[114:115]
    ds_write_b64 v113, v[114:115] offset:8
    v_mfma_f32_16x16x32_bf16 v[100:103], a[52:55], v[36:39], v[100:103]
    s_add_u32 m0, s32, 34816
    s_nop 0
    buffer_load_dwordx4 v4, s[12:15], s79 offen offset:1024 lds
    buffer_load_dwordx4 v4, s[12:15], s79 offen offset:2048 lds
    v_mfma_f32_16x16x32_bf16 v[96:99], a[48:51], v[40:43], v[96:99]
    s_add_u32 m0, s31, 69632
    s_nop 0
    buffer_load_dwordx4 v2, s[8:11], s72 offen lds
    buffer_load_dwordx4 v3, s[8:11], s72 offen offset:1024 lds
    v_mfma_f32_16x16x32_bf16 v[104:107], a[52:55], v[40:43], v[104:107]
    s_waitcnt vmcnt(8) lgkmcnt(0)
    s_barrier
    v_mfma_f32_16x16x32_bf16 v[76:79], a[56:59], v[44:47], v[76:79]
    ds_read_b128 a[64:67], v6 offset:0
    ds_read_b64_tr_b16 v[28:29], v10 offset:18432
    v_mfma_f32_16x16x32_bf16 v[84:87], a[60:63], v[44:47], v[84:87]
    ds_read_b64_tr_b16 v[30:31], v10 offset:18944
    ds_read_b128 a[68:71], v6 offset:2048
    v_mfma_f32_16x16x32_bf16 v[80:83], a[56:59], v[48:51], v[80:83]
    ds_read_b64_tr_b16 v[32:33], v11 offset:18432
    ds_read_b64_tr_b16 v[34:35], v11 offset:18944
    v_mfma_f32_16x16x32_bf16 v[88:91], a[60:63], v[48:51], v[88:91]
    ds_read_b64_tr_b16 v[36:37], v10 offset:19456
    ds_read_b64_tr_b16 v[38:39], v10 offset:19968
    v_mfma_f32_16x16x32_bf16 v[92:95], a[56:59], v[52:55], v[92:95]
    ds_read_b64_tr_b16 v[40:41], v11 offset:19456
    ds_read_b64_tr_b16 v[42:43], v11 offset:19968
    v_mfma_f32_16x16x32_bf16 v[100:103], a[60:63], v[52:55], v[100:103]
    s_add_u32 m0, s32, 69632
    s_nop 0
    buffer_load_dwordx4 v4, s[12:15], s80 offen offset:1024 lds
    buffer_load_dwordx4 v4, s[12:15], s80 offen offset:2048 lds
    v_mfma_f32_16x16x32_bf16 v[96:99], a[56:59], v[56:59], v[96:99]
    s_add_u32 m0, s31, 104448
    s_nop 0
    buffer_load_dwordx4 v2, s[8:11], s73 offen lds
    buffer_load_dwordx4 v3, s[8:11], s73 offen offset:1024 lds
    v_mfma_f32_16x16x32_bf16 v[104:107], a[60:63], v[56:59], v[104:107]
    s_waitcnt lgkmcnt(0)
    v_mfma_f32_16x16x32_bf16 v[76:79], a[64:67], v[28:31], v[76:79]
    ds_read_b128 a[72:75], v7 offset:0
    ds_read_b64_tr_b16 v[44:45], v10 offset:26624
    v_mfma_f32_16x16x32_bf16 v[84:87], a[68:71], v[28:31], v[84:87]
    ds_read_b64_tr_b16 v[46:47], v10 offset:27136
    ds_read_b128 a[76:79], v7 offset:2048
    v_mfma_f32_16x16x32_bf16 v[80:83], a[64:67], v[32:35], v[80:83]
    ds_read_b64_tr_b16 v[48:49], v11 offset:26624
    ds_read_b64_tr_b16 v[50:51], v11 offset:27136
    v_mfma_f32_16x16x32_bf16 v[88:91], a[68:71], v[32:35], v[88:91]
    ds_read_b64_tr_b16 v[52:53], v10 offset:27648
    ds_read_b64_tr_b16 v[54:55], v10 offset:28160
    v_mfma_f32_16x16x32_bf16 v[92:95], a[64:67], v[36:39], v[92:95]
    ds_read_b64_tr_b16 v[56:57], v11 offset:27648
    ds_read_b64_tr_b16 v[58:59], v11 offset:28160
    v_mfma_f32_16x16x32_bf16 v[100:103], a[68:71], v[36:39], v[100:103]
    s_add_u32 m0, s32, 104448
    s_nop 0
    buffer_load_dwordx4 v4, s[12:15], s81 offen offset:1024 lds
    buffer_load_dwordx4 v4, s[12:15], s81 offen offset:2048 lds
    v_mfma_f32_16x16x32_bf16 v[96:99], a[64:67], v[40:43], v[96:99]
    v_mfma_f32_16x16x32_bf16 v[104:107], a[68:71], v[40:43], v[104:107]
    s_waitcnt vmcnt(8) lgkmcnt(0)
    s_barrier
    v_mfma_f32_16x16x32_bf16 v[76:79], a[72:75], v[44:47], v[76:79]
    ds_read_b128 a[80:83], v6 offset:34816
    ds_read_b64_tr_b16 v[28:29], v10 offset:53248
    v_mfma_f32_16x16x32_bf16 v[84:87], a[76:79], v[44:47], v[84:87]
    ds_read_b64_tr_b16 v[30:31], v10 offset:53760
    ds_read_b128 a[84:87], v6 offset:36864
    v_mfma_f32_16x16x32_bf16 v[80:83], a[72:75], v[48:51], v[80:83]
    ds_read_b64_tr_b16 v[32:33], v11 offset:53248
    ds_read_b64_tr_b16 v[34:35], v11 offset:53760
    v_mfma_f32_16x16x32_bf16 v[88:91], a[76:79], v[48:51], v[88:91]
    ds_read_b64_tr_b16 v[36:37], v10 offset:54272
    ds_read_b64_tr_b16 v[38:39], v10 offset:54784
    v_mfma_f32_16x16x32_bf16 v[92:95], a[72:75], v[52:55], v[92:95]
    ds_read_b64_tr_b16 v[40:41], v11 offset:54272
    ds_read_b64_tr_b16 v[42:43], v11 offset:54784
    v_mfma_f32_16x16x32_bf16 v[100:103], a[76:79], v[52:55], v[100:103]
    s_add_u32 m0, s31, 0
    s_nop 0
    buffer_load_dwordx4 v4, s[12:15], s74 offen lds
    v_mfma_f32_16x16x32_bf16 v[96:99], a[72:75], v[56:59], v[96:99]
    s_add_u32 m0, s31, 1024
    s_nop 0
    buffer_load_dwordx4 v4, s[12:15], s75 offen lds
    v_mfma_f32_16x16x32_bf16 v[104:107], a[76:79], v[56:59], v[104:107]
    s_waitcnt lgkmcnt(0)
    v_mfma_f32_16x16x32_bf16 v[76:79], a[80:83], v[28:31], v[76:79]
    ds_read_b128 a[88:91], v7 offset:34816
    ds_read_b64_tr_b16 v[44:45], v10 offset:61440
    v_mfma_f32_16x16x32_bf16 v[84:87], a[84:87], v[28:31], v[84:87]
    ds_read_b64_tr_b16 v[46:47], v10 offset:61952
    ds_read_b128 a[92:95], v7 offset:36864
    v_mfma_f32_16x16x32_bf16 v[80:83], a[80:83], v[32:35], v[80:83]
    ds_read_b64_tr_b16 v[48:49], v11 offset:61440
    ds_read_b64_tr_b16 v[50:51], v11 offset:61952
    v_mfma_f32_16x16x32_bf16 v[88:91], a[84:87], v[32:35], v[88:91]
    ds_read_b64_tr_b16 v[52:53], v10 offset:62464
    ds_read_b64_tr_b16 v[54:55], v10 offset:62976
    v_mfma_f32_16x16x32_bf16 v[92:95], a[80:83], v[36:39], v[92:95]
    ds_read_b64_tr_b16 v[56:57], v11 offset:62464
    ds_read_b64_tr_b16 v[58:59], v11 offset:62976
    v_mfma_f32_16x16x32_bf16 v[100:103], a[84:87], v[36:39], v[100:103]
    s_add_u32 m0, s31, 16384
    s_nop 0
    buffer_load_dwordx4 v4, s[12:15], s76 offen lds
    v_mfma_f32_16x16x32_bf16 v[96:99], a[80:83], v[40:43], v[96:99]
    s_add_u32 m0, s31, 17408
    s_nop 0
    buffer_load_dwordx4 v4, s[12:15], s77 offen lds
    v_mfma_f32_16x16x32_bf16 v[104:107], a[84:87], v[40:43], v[104:107]
    s_waitcnt vmcnt(8) lgkmcnt(0)
    s_barrier
    v_mfma_f32_16x16x32_bf16 v[76:79], a[88:91], v[44:47], v[76:79]
    ds_read_b128 a[96:99], v8 offset:0
    ds_read_b64_tr_b16 v[28:29], v12 offset:18432
    v_mfma_f32_16x16x32_bf16 v[84:87], a[92:95], v[44:47], v[84:87]
    ds_read_b64_tr_b16 v[30:31], v12 offset:18944
    ds_read_b128 a[100:103], v8 offset:2048
    v_mfma_f32_16x16x32_bf16 v[80:83], a[88:91], v[48:51], v[80:83]
    ds_read_b64_tr_b16 v[32:33], v13 offset:18432
    ds_read_b64_tr_b16 v[34:35], v13 offset:18944
    v_mfma_f32_16x16x32_bf16 v[88:91], a[92:95], v[48:51], v[88:91]
    ds_read_b64_tr_b16 v[36:37], v12 offset:19456
    ds_read_b64_tr_b16 v[38:39], v12 offset:19968
    v_mfma_f32_16x16x32_bf16 v[92:95], a[88:91], v[52:55], v[92:95]
    ds_read_b64_tr_b16 v[40:41], v13 offset:19456
    ds_read_b64_tr_b16 v[42:43], v13 offset:19968
    v_mfma_f32_16x16x32_bf16 v[100:103], a[92:95], v[52:55], v[100:103]
    s_add_u32 m0, s31, 34816
    s_nop 0
    buffer_load_dwordx4 v4, s[12:15], s78 offen lds
    v_mfma_f32_16x16x32_bf16 v[96:99], a[88:91], v[56:59], v[96:99]
    s_add_u32 m0, s31, 35840
    s_nop 0
    buffer_load_dwordx4 v4, s[12:15], s79 offen lds
    v_mfma_f32_16x16x32_bf16 v[104:107], a[92:95], v[56:59], v[104:107]
    s_waitcnt lgkmcnt(0)
    v_mfma_f32_16x16x32_bf16 v[76:79], a[96:99], v[28:31], v[76:79]
    ds_read_b128 a[104:107], v9 offset:0
    ds_read_b64_tr_b16 v[44:45], v12 offset:26624
    v_mfma_f32_16x16x32_bf16 v[84:87], a[100:103], v[28:31], v[84:87]
    ds_read_b64_tr_b16 v[46:47], v12 offset:27136
    ds_read_b128 a[108:111], v9 offset:2048
    v_mfma_f32_16x16x32_bf16 v[80:83], a[96:99], v[32:35], v[80:83]
    ds_read_b64_tr_b16 v[48:49], v13 offset:26624
    ds_read_b64_tr_b16 v[50:51], v13 offset:27136
    v_mfma_f32_16x16x32_bf16 v[88:91], a[100:103], v[32:35], v[88:91]
    ds_read_b64_tr_b16 v[52:53], v12 offset:27648
    ds_read_b64_tr_b16 v[54:55], v12 offset:28160
    v_mfma_f32_16x16x32_bf16 v[92:95], a[96:99], v[36:39], v[92:95]
    ds_read_b64_tr_b16 v[56:57], v13 offset:27648
    ds_read_b64_tr_b16 v[58:59], v13 offset:28160
    v_mfma_f32_16x16x32_bf16 v[100:103], a[100:103], v[36:39], v[100:103]
    s_add_u32 m0, s31, 51200
    s_nop 0
    buffer_load_dwordx4 v4, s[12:15], s80 offen lds
    v_mfma_f32_16x16x32_bf16 v[96:99], a[96:99], v[40:43], v[96:99]
    s_add_u32 m0, s31, 52224
    s_nop 0
    buffer_load_dwordx4 v4, s[12:15], s81 offen lds
    v_mfma_f32_16x16x32_bf16 v[104:107], a[100:103], v[40:43], v[104:107]
    s_waitcnt vmcnt(8) lgkmcnt(0)
    s_barrier
    v_mfma_f32_16x16x32_bf16 v[76:79], a[104:107], v[44:47], v[76:79]
    ds_read_b128 a[112:115], v8 offset:34816
    ds_read_b64_tr_b16 v[28:29], v12 offset:53248
    v_mfma_f32_16x16x32_bf16 v[84:87], a[108:111], v[44:47], v[84:87]
    ds_read_b64_tr_b16 v[30:31], v12 offset:53760
    ds_read_b128 a[116:119], v8 offset:36864
    v_mfma_f32_16x16x32_bf16 v[80:83], a[104:107], v[48:51], v[80:83]
    ds_read_b64_tr_b16 v[32:33], v13 offset:53248
    ds_read_b64_tr_b16 v[34:35], v13 offset:53760
    v_mfma_f32_16x16x32_bf16 v[88:91], a[108:111], v[48:51], v[88:91]
    ds_read_b64_tr_b16 v[36:37], v12 offset:54272
    ds_read_b64_tr_b16 v[38:39], v12 offset:54784
    v_mfma_f32_16x16x32_bf16 v[92:95], a[104:107], v[52:55], v[92:95]
    ds_read_b64_tr_b16 v[40:41], v13 offset:54272
    ds_read_b64_tr_b16 v[42:43], v13 offset:54784
    v_mfma_f32_16x16x32_bf16 v[100:103], a[108:111], v[52:55], v[100:103]
    v_mfma_f32_16x16x32_bf16 v[96:99], a[104:107], v[56:59], v[96:99]
    v_mfma_f32_16x16x32_bf16 v[104:107], a[108:111], v[56:59], v[104:107]
    s_waitcnt lgkmcnt(0)
    v_mfma_f32_16x16x32_bf16 v[76:79], a[112:115], v[28:31], v[76:79]
    ds_read_b128 a[120:123], v9 offset:34816
    ds_read_b64_tr_b16 v[44:45], v12 offset:61440
    v_mfma_f32_16x16x32_bf16 v[84:87], a[116:119], v[28:31], v[84:87]
    ds_read_b64_tr_b16 v[46:47], v12 offset:61952
    ds_read_b128 a[124:127], v9 offset:36864
    v_mfma_f32_16x16x32_bf16 v[80:83], a[112:115], v[32:35], v[80:83]
    ds_read_b64_tr_b16 v[48:49], v13 offset:61440
    ds_read_b64_tr_b16 v[50:51], v13 offset:61952
    v_mfma_f32_16x16x32_bf16 v[88:91], a[116:119], v[32:35], v[88:91]
    ds_read_b64_tr_b16 v[52:53], v12 offset:62464
    ds_read_b64_tr_b16 v[54:55], v12 offset:62976
    v_mfma_f32_16x16x32_bf16 v[92:95], a[112:115], v[36:39], v[92:95]
    ds_read_b64_tr_b16 v[56:57], v13 offset:62464
    ds_read_b64_tr_b16 v[58:59], v13 offset:62976
    v_mfma_f32_16x16x32_bf16 v[100:103], a[116:119], v[36:39], v[100:103]
    v_mfma_f32_16x16x32_bf16 v[96:99], a[112:115], v[40:43], v[96:99]
    v_mfma_f32_16x16x32_bf16 v[104:107], a[116:119], v[40:43], v[104:107]
    s_waitcnt lgkmcnt(0)
    v_mfma_f32_16x16x32_bf16 v[76:79], a[120:123], v[44:47], v[76:79]
    v_mfma_f32_16x16x32_bf16 v[84:87], a[124:127], v[44:47], v[84:87]
    v_mfma_f32_16x16x32_bf16 v[80:83], a[120:123], v[48:51], v[80:83]
    v_mfma_f32_16x16x32_bf16 v[88:91], a[124:127], v[48:51], v[88:91]
    v_mfma_f32_16x16x32_bf16 v[92:95], a[120:123], v[52:55], v[92:95]
    v_mfma_f32_16x16x32_bf16 v[100:103], a[124:127], v[52:55], v[100:103]
    v_mfma_f32_16x16x32_bf16 v[96:99], a[120:123], v[56:59], v[96:99]
    v_mfma_f32_16x16x32_bf16 v[104:107], a[124:127], v[56:59], v[104:107]
    s_nop 0
    v_mul_f32 v28, v76, v20
    v_mul_f32 v29, v77, v20
    v_mul_f32 v30, v78, v20
    v_mul_f32 v31, v79, v20
    v_mul_f32 v32, v80, v20
    v_mul_f32 v33, v81, v20
    v_mul_f32 v34, v82, v20
    v_mul_f32 v35, v83, v20
    v_exp_f32_e64 v28, v28 clamp
    v_exp_f32_e64 v29, v29 clamp
    v_exp_f32_e64 v30, v30 clamp
    v_exp_f32_e64 v31, v31 clamp
    v_exp_f32_e64 v32, v32 clamp
    v_exp_f32_e64 v33, v33 clamp
    v_exp_f32_e64 v34, v34 clamp
    v_exp_f32_e64 v35, v35 clamp
    v_add_f32_e64 v76, v76, abs(v76)
    v_add_f32_e64 v77, v77, abs(v77)
    v_add_f32_e64 v78, v78, abs(v78)
    v_add_f32_e64 v79, v79, abs(v79)
    v_add_f32_e64 v80, v80, abs(v80)
    v_add_f32_e64 v81, v81, abs(v81)
    v_add_f32_e64 v82, v82, abs(v82)
    v_add_f32_e64 v83, v83, abs(v83)
    v_add_f32 v28, v28, v21
    v_add_f32 v29, v29, v21
    v_add_f32 v30, v30, v21
    v_add_f32 v31, v31, v21
    v_add_f32 v32, v32, v21
    v_add_f32 v33, v33, v21
    v_add_f32 v34, v34, v21
    v_add_f32 v35, v35, v21
    v_fma_f32 v76, v76, 0.5, v28
    v_fma_f32 v77, v77, 0.5, v29
    v_fma_f32 v78, v78, 0.5, v30
    v_fma_f32 v79, v79, 0.5, v31
    v_fma_f32 v80, v80, 0.5, v32
    v_fma_f32 v81, v81, 0.5, v33
    v_fma_f32 v82, v82, 0.5, v34
    v_fma_f32 v83, v83, 0.5, v35
    v_cvt_pk_bf16_f32 v52, v92, v93
    v_cvt_pk_bf16_f32 v53, v94, v95
    v_cvt_pk_bf16_f32 v54, v100, v101
    v_cvt_pk_bf16_f32 v55, v102, v103
    v_cvt_pk_bf16_f32 v56, v96, v97
    v_cvt_pk_bf16_f32 v57, v98, v99
    v_cvt_pk_bf16_f32 v58, v104, v105
    v_cvt_pk_bf16_f32 v59, v106, v107
    v_mul_f32 v36, v84, v20
    v_mul_f32 v37, v85, v20
    v_mul_f32 v38, v86, v20
    v_mul_f32 v39, v87, v20
    v_mul_f32 v40, v88, v20
    v_mul_f32 v41, v89, v20
    v_mul_f32 v42, v90, v20
    v_mul_f32 v43, v91, v20
    v_exp_f32_e64 v36, v36 clamp
    v_exp_f32_e64 v37, v37 clamp
    v_exp_f32_e64 v38, v38 clamp
    v_exp_f32_e64 v39, v39 clamp
    v_exp_f32_e64 v40, v40 clamp
    v_exp_f32_e64 v41, v41 clamp
    v_exp_f32_e64 v42, v42 clamp
    v_exp_f32_e64 v43, v43 clamp
    v_add_f32_e64 v84, v84, abs(v84)
    v_add_f32_e64 v85, v85, abs(v85)
    v_add_f32_e64 v86, v86, abs(v86)
    v_add_f32_e64 v87, v87, abs(v87)
    v_add_f32_e64 v88, v88, abs(v88)
    v_add_f32_e64 v89, v89, abs(v89)
    v_add_f32_e64 v90, v90, abs(v90)
    v_add_f32_e64 v91, v91, abs(v91)
    v_add_f32 v36, v36, v21
    v_add_f32 v37, v37, v21
    v_add_f32 v38, v38, v21
    v_add_f32 v39, v39, v21
    v_add_f32 v40, v40, v21
    v_add_f32 v41, v41, v21
    v_add_f32 v42, v42, v21
    v_add_f32 v43, v43, v21
    v_fma_f32 v84, v84, 0.5, v36
    v_fma_f32 v85, v85, 0.5, v37
    v_fma_f32 v86, v86, 0.5, v38
    v_fma_f32 v87, v87, 0.5, v39
    v_fma_f32 v88, v88, 0.5, v40
    v_fma_f32 v89, v89, 0.5, v41
    v_fma_f32 v90, v90, 0.5, v42
    v_fma_f32 v91, v91, 0.5, v43
    v_cvt_pk_bf16_f32 v44, v76, v77
    v_cvt_pk_bf16_f32 v45, v78, v79
    v_cvt_pk_bf16_f32 v46, v84, v85
    v_cvt_pk_bf16_f32 v47, v86, v87
    v_cvt_pk_bf16_f32 v48, v80, v81
    v_cvt_pk_bf16_f32 v49, v82, v83
    v_cvt_pk_bf16_f32 v50, v88, v89
    v_cvt_pk_bf16_f32 v51, v90, v91
    v_mfma_f32_16x16x32_bf16 v[76:79], v[44:47], v[52:55], 0
    v_mfma_f32_16x16x32_bf16 v[84:87], v[60:63], v[44:47], 0
    v_mfma_f32_16x16x32_bf16 v[80:83], v[48:51], v[56:59], 0
    v_mfma_f32_16x16x32_bf16 v[88:91], v[60:63], v[48:51], 0
    s_waitcnt vmcnt(20)
    s_mov_b32 s43, 0
NW_1:
    v_readfirstlane_b32 s40, v22
    s_nop 3
    s_cmp_lg_u32 s40, 0
    s_cbranch_scc1 NOK_2
    s_add_u32 s43, s43, 1
    s_cmp_ge_u32 s43, 131072
    s_cbranch_scc1 NOK_2
    v_mov_b32 v27, 0
    global_load_dword v22, v27, s[58:59] sc1
    s_waitcnt vmcnt(0)
    s_branch NW_1
NOK_2:
    ds_write_b128 v64, v[76:79] offset:0
    ds_write_b32 v65, v84 offset:0
    ds_write_b128 v64, v[80:83] offset:4096
    ds_write_b32 v65, v88 offset:256
    s_waitcnt lgkmcnt(0)
    s_barrier
    ds_read_b128 v[28:31], v66 offset:0
    ds_read_b32 v44, v67 offset:0
    ds_read_b128 v[32:35], v66 offset:1024
    ds_read_b32 v45, v67 offset:64
    ds_read_b128 v[36:39], v66 offset:2048
    ds_read_b32 v46, v67 offset:128
    ds_read_b128 v[40:43], v66 offset:3072
    ds_read_b32 v47, v67 offset:192
    v_mov_b32 v51, s40
    v_lshrrev_b32 v24, 3, v1
    v_lshrrev_b32 v25, 4, v1
    v_lshlrev_b32 v25, 1, v25
    v_and_b32 v26, 7, v1
    v_xor_b32 v25, v25, v26
    v_lshlrev_b32 v25, 4, v25
    v_lshl_add_u32 v5, v24, 10, v25
    v_add_u32 v5, s65, v5
    s_lshl_b32 s33, s24, 10
    s_waitcnt lgkmcnt(0)
    v_add_f32 v28, v28, v32
    v_add_f32 v36, v36, v40
    v_add_f32 v29, v29, v33
    v_add_f32 v37, v37, v41
    v_add_f32 v30, v30, v34
    v_add_f32 v38, v38, v42
    v_add_f32 v31, v31, v35
    v_add_f32 v39, v39, v43
    v_add_f32 v44, v44, v45
    v_add_f32 v46, v46, v47
    v_add_f32 v28, v28, v36
    v_add_f32 v29, v29, v37
    v_add_f32 v30, v30, v38
    v_add_f32 v31, v31, v39
    v_add_f32 v50, v44, v46
    v_cvt_pk_bf16_f32 v48, v28, v29
    v_cvt_pk_bf16_f32 v49, v30, v31
    buffer_store_dwordx4 v[48:51], v72, s[16:19], s94 offen sc1
    s_waitcnt vmcnt(5) lgkmcnt(0)
    s_barrier
    ds_read_b64_tr_b16 v[28:29], v10 offset:0
    ds_read_b64_tr_b16 v[30:31], v10 offset:512
    ds_read_b64_tr_b16 v[32:33], v10 offset:8192
    ds_read_b64_tr_b16 v[34:35], v10 offset:8704
    ds_read_b64_tr_b16 v[36:37], v10 offset:1024
    ds_read_b64_tr_b16 v[38:39], v10 offset:1536
    ds_read_b64_tr_b16 v[40:41], v10 offset:9216
    ds_read_b64_tr_b16 v[42:43], v10 offset:9728
    s_waitcnt lgkmcnt(0)
    v_mfma_f32_16x16x32_bf16 v[108:111], v[28:31], a[0:3], 0
    ds_read_b64_tr_b16 v[44:45], v10 offset:16384
    ds_read_b64_tr_b16 v[46:47], v10 offset:16896
    v_mfma_f32_16x16x32_bf16 v[116:119], v[28:31], a[4:7], 0
    ds_read_b64_tr_b16 v[48:49], v10 offset:24576
    ds_read_b64_tr_b16 v[50:51], v10 offset:25088
    v_mfma_f32_16x16x32_bf16 v[108:111], v[32:35], a[8:11], v[108:111]
    ds_read_b64_tr_b16 v[52:53], v10 offset:17408
    ds_read_b64_tr_b16 v[54:55], v10 offset:17920
    v_mfma_f32_16x16x32_bf16 v[116:119], v[32:35], a[12:15], v[116:119]
    ds_read_b64_tr_b16 v[56:57], v10 offset:25600
    ds_read_b64_tr_b16 v[58:59], v10 offset:26112
    v_mfma_f32_16x16x32_bf16 v[108:111], v[36:39], a[16:19], v[108:111]
    s_lshl_b32 s34, s66, 9
    s_add_u32 m0, s33, 73728
    s_nop 0
    buffer_load_dwordx4 v5, s[20:23], s34 offen lds
    v_mfma_f32_16x16x32_bf16 v[116:119], v[36:39], a[20:23], v[116:119]
    v_mfma_f32_16x16x32_bf16 v[108:111], v[40:43], a[24:27], v[108:111]
    s_lshl_b32 s34, s67, 9
    s_add_u32 m0, s33, 81920
    s_nop 0
    buffer_load_dwordx4 v5, s[20:23], s34 offen lds
    v_mfma_f32_16x16x32_bf16 v[116:119], v[40:43], a[28:31], v[116:119]
    s_waitcnt vmcnt(3) lgkmcnt(0)
    s_barrier
    v_mfma_f32_16x16x32_bf16 v[108:111], v[44:47], a[32:35], v[108:111]
    ds_read_b64_tr_b16 v[28:29], v10 offset:34816
    ds_read_b64_tr_b16 v[30:31], v10 offset:35328
    v_mfma_f32_16x16x32_bf16 v[116:119], v[44:47], a[36:39], v[116:119]
    ds_read_b64_tr_b16 v[32:33], v10 offset:43008
    ds_read_b64_tr_b16 v[34:35], v10 offset:43520
    v_mfma_f32_16x16x32_bf16 v[108:111], v[48:51], a[40:43], v[108:111]
    ds_read_b64_tr_b16 v[36:37], v10 offset:35840
    ds_read_b64_tr_b16 v[38:39], v10 offset:36352
    v_mfma_f32_16x16x32_bf16 v[116:119], v[48:51], a[44:47], v[116:119]
    ds_read_b64_tr_b16 v[40:41], v10 offset:44032
    ds_read_b64_tr_b16 v[42:43], v10 offset:44544
    v_mfma_f32_16x16x32_bf16 v[108:111], v[52:55], a[48:51], v[108:111]
    s_lshl_b32 s34, s68, 9
    s_add_u32 m0, s33, 90112
    s_nop 0
    buffer_load_dwordx4 v5, s[20:23], s34 offen lds
    v_mfma_f32_16x16x32_bf16 v[116:119], v[52:55], a[52:55], v[116:119]
    v_mfma_f32_16x16x32_bf16 v[108:111], v[56:59], a[56:59], v[108:111]
    s_lshl_b32 s34, s69, 9
    s_add_u32 m0, s33, 98304
    s_nop 0
    buffer_load_dwordx4 v5, s[20:23], s34 offen lds
    v_mfma_f32_16x16x32_bf16 v[116:119], v[56:59], a[60:63], v[116:119]
    s_waitcnt lgkmcnt(0)
    v_mfma_f32_16x16x32_bf16 v[108:111], v[28:31], a[64:67], v[108:111]
    ds_read_b64_tr_b16 v[44:45], v10 offset:51200
    ds_read_b64_tr_b16 v[46:47], v10 offset:51712
    v_mfma_f32_16x16x32_bf16 v[116:119], v[28:31], a[68:71], v[116:119]
    ds_read_b64_tr_b16 v[48:49], v10 offset:59392
    ds_read_b64_tr_b16 v[50:51], v10 offset:59904
    v_mfma_f32_16x16x32_bf16 v[108:111], v[32:35], a[72:75], v[108:111]
    ds_read_b64_tr_b16 v[52:53], v10 offset:52224
    ds_read_b64_tr_b16 v[54:55], v10 offset:52736
    v_mfma_f32_16x16x32_bf16 v[116:119], v[32:35], a[76:79], v[116:119]
    ds_read_b64_tr_b16 v[56:57], v10 offset:60416
    ds_read_b64_tr_b16 v[58:59], v10 offset:60928
    v_mfma_f32_16x16x32_bf16 v[108:111], v[36:39], a[80:83], v[108:111]
    s_lshl_b32 s34, s70, 9
    s_add_u32 m0, s33, 106496
    s_nop 0
    buffer_load_dwordx4 v5, s[20:23], s34 offen lds
    v_mfma_f32_16x16x32_bf16 v[116:119], v[36:39], a[84:87], v[116:119]
    v_mfma_f32_16x16x32_bf16 v[108:111], v[40:43], a[88:91], v[108:111]
    s_lshl_b32 s34, s71, 9
    s_add_u32 m0, s33, 114688
    s_nop 0
    buffer_load_dwordx4 v5, s[20:23], s34 offen lds
    v_mfma_f32_16x16x32_bf16 v[116:119], v[40:43], a[92:95], v[116:119]
    s_waitcnt lgkmcnt(0)
    v_mfma_f32_16x16x32_bf16 v[108:111], v[44:47], a[96:99], v[108:111]
    ds_read_b64_tr_b16 v[28:29], v11 offset:0
    ds_read_b64_tr_b16 v[30:31], v11 offset:512
    v_mfma_f32_16x16x32_bf16 v[116:119], v[44:47], a[100:103], v[116:119]
    ds_read_b64_tr_b16 v[32:33], v11 offset:8192
    ds_read_b64_tr_b16 v[34:35], v11 offset:8704
    v_mfma_f32_16x16x32_bf16 v[108:111], v[48:51], a[104:107], v[108:111]
    ds_read_b64_tr_b16 v[36:37], v11 offset:1024
    ds_read_b64_tr_b16 v[38:39], v11 offset:1536
    v_mfma_f32_16x16x32_bf16 v[116:119], v[48:51], a[108:111], v[116:119]
    ds_read_b64_tr_b16 v[40:41], v11 offset:9216
    ds_read_b64_tr_b16 v[42:43], v11 offset:9728
    v_mfma_f32_16x16x32_bf16 v[108:111], v[52:55], a[112:115], v[108:111]
    s_lshl_b32 s34, s72, 9
    s_add_u32 m0, s33, 122880
    s_nop 0
    buffer_load_dwordx4 v5, s[20:23], s34 offen lds
    v_mfma_f32_16x16x32_bf16 v[116:119], v[52:55], a[116:119], v[116:119]
    s_lshl_b32 s34, s73, 9
    s_add_u32 m0, s33, 131072
    s_nop 0
    buffer_load_dwordx4 v5, s[20:23], s34 offen lds
    v_mfma_f32_16x16x32_bf16 v[108:111], v[56:59], a[120:123], v[108:111]
    s_cmp_lg_u32 s24, 7
    s_cbranch_scc1 WT_1002
    s_lshr_b32 s34, s2, 3
    s_and_b32 s34, s34, 7
    s_lshl_b32 s34, s34, 16
    s_lshl_b32 s35, s55, 7
    s_add_u32 s34, s34, s35
    v_lshlrev_b32 v74, 10, v1
    buffer_load_dword v73, v74, s[4:7], s34 offen
    buffer_load_dword v73, v74, s[20:23], s34 offen
WT_1002:
    v_mfma_f32_16x16x32_bf16 v[116:119], v[56:59], a[124:127], v[116:119]
    s_waitcnt lgkmcnt(0)
    v_mfma_f32_16x16x32_bf16 v[112:115], v[28:31], a[0:3], 0
    ds_read_b64_tr_b16 v[44:45], v11 offset:16384
    ds_read_b64_tr_b16 v[46:47], v11 offset:16896
    v_mfma_f32_16x16x32_bf16 v[120:123], v[28:31], a[4:7], 0
    ds_read_b64_tr_b16 v[48:49], v11 offset:24576
    ds_read_b64_tr_b16 v[50:51], v11 offset:25088
    v_mfma_f32_16x16x32_bf16 v[112:115], v[32:35], a[8:11], v[112:115]
    ds_read_b64_tr_b16 v[52:53], v11 offset:17408
    ds_read_b64_tr_b16 v[54:55], v11 offset:17920
    v_mfma_f32_16x16x32_bf16 v[120:123], v[32:35], a[12:15], v[120:123]
    ds_read_b64_tr_b16 v[56:57], v11 offset:25600
    ds_read_b64_tr_b16 v[58:59], v11 offset:26112
    v_mfma_f32_16x16x32_bf16 v[112:115], v[36:39], a[16:19], v[112:115]
    v_mfma_f32_16x16x32_bf16 v[120:123], v[36:39], a[20:23], v[120:123]
    v_mfma_f32_16x16x32_bf16 v[112:115], v[40:43], a[24:27], v[112:115]
    v_mfma_f32_16x16x32_bf16 v[120:123], v[40:43], a[28:31], v[120:123]
    s_waitcnt lgkmcnt(0)
    v_mfma_f32_16x16x32_bf16 v[112:115], v[44:47], a[32:35], v[112:115]
    ds_read_b64_tr_b16 v[28:29], v11 offset:34816
    ds_read_b64_tr_b16 v[30:31], v11 offset:35328
    v_mul_f32 v124, v108, v20
    v_mfma_f32_16x16x32_bf16 v[120:123], v[44:47], a[36:39], v[120:123]
    ds_read_b64_tr_b16 v[32:33], v11 offset:43008
    ds_read_b64_tr_b16 v[34:35], v11 offset:43520
    v_mul_f32 v125, v109, v20
    v_mfma_f32_16x16x32_bf16 v[112:115], v[48:51], a[40:43], v[112:115]
    ds_read_b64_tr_b16 v[36:37], v11 offset:35840
    ds_read_b64_tr_b16 v[38:39], v11 offset:36352
    v_mul_f32 v126, v110, v20
    v_mfma_f32_16x16x32_bf16 v[120:123], v[48:51], a[44:47], v[120:123]
    ds_read_b64_tr_b16 v[40:41], v11 offset:44032
    ds_read_b64_tr_b16 v[42:43], v11 offset:44544
    v_mul_f32 v127, v111, v20
    v_exp_f32_e64 v124, v124 clamp
    v_exp_f32_e64 v125, v125 clamp
    v_mfma_f32_16x16x32_bf16 v[112:115], v[52:55], a[48:51], v[112:115]
    v_exp_f32_e64 v126, v126 clamp
    v_exp_f32_e64 v127, v127 clamp
    v_add_f32_e64 v108, v108, abs(v108)
    v_mfma_f32_16x16x32_bf16 v[120:123], v[52:55], a[52:55], v[120:123]
    v_add_f32_e64 v109, v109, abs(v109)
    v_add_f32_e64 v110, v110, abs(v110)
    v_add_f32_e64 v111, v111, abs(v111)
    v_mfma_f32_16x16x32_bf16 v[112:115], v[56:59], a[56:59], v[112:115]
    v_add_f32 v124, v124, v21
    v_add_f32 v125, v125, v21
    v_add_f32 v126, v126, v21
    v_mfma_f32_16x16x32_bf16 v[120:123], v[56:59], a[60:63], v[120:123]
    v_add_f32 v127, v127, v21
    v_fma_f32 v108, v108, 0.5, v124
    v_fma_f32 v109, v109, 0.5, v125
    s_waitcnt lgkmcnt(0)
    v_mfma_f32_16x16x32_bf16 v[112:115], v[28:31], a[64:67], v[112:115]
    ds_read_b64_tr_b16 v[44:45], v11 offset:51200
    ds_read_b64_tr_b16 v[46:47], v11 offset:51712
    v_fma_f32 v110, v110, 0.5, v126
    v_mfma_f32_16x16x32_bf16 v[120:123], v[28:31], a[68:71], v[120:123]
    ds_read_b64_tr_b16 v[48:49], v11 offset:59392
    ds_read_b64_tr_b16 v[50:51], v11 offset:59904
    v_fma_f32 v111, v111, 0.5, v127
    v_mfma_f32_16x16x32_bf16 v[112:115], v[32:35], a[72:75], v[112:115]
    ds_read_b64_tr_b16 v[52:53], v11 offset:52224
    ds_read_b64_tr_b16 v[54:55], v11 offset:52736
    v_mul_f32 v60, v116, v20
    v_mfma_f32_16x16x32_bf16 v[120:123], v[32:35], a[76:79], v[120:123]
    ds_read_b64_tr_b16 v[56:57], v11 offset:60416
    ds_read_b64_tr_b16 v[58:59], v11 offset:60928
    v_mul_f32 v61, v117, v20
    v_mul_f32 v62, v118, v20
    v_mul_f32 v63, v119, v20
    v_mfma_f32_16x16x32_bf16 v[112:115], v[36:39], a[80:83], v[112:115]
    buffer_load_dwordx4 v[76:79], v72, s[16:19], s86 offen sc1
    v_exp_f32_e64 v60, v60 clamp
    v_mfma_f32_16x16x32_bf16 v[120:123], v[36:39], a[84:87], v[120:123]
    buffer_load_dwordx4 v[80:83], v72, s[16:19], s87 offen sc1
    v_exp_f32_e64 v61, v61 clamp
    v_mfma_f32_16x16x32_bf16 v[112:115], v[40:43], a[88:91], v[112:115]
    buffer_load_dwordx4 v[84:87], v72, s[16:19], s88 offen sc1
    v_exp_f32_e64 v62, v62 clamp
    v_mfma_f32_16x16x32_bf16 v[120:123], v[40:43], a[92:95], v[120:123]
    buffer_load_dwordx4 v[88:91], v72, s[16:19], s89 offen sc1
    v_exp_f32_e64 v63, v63 clamp
    s_waitcnt lgkmcnt(0)
    v_mfma_f32_16x16x32_bf16 v[112:115], v[44:47], a[96:99], v[112:115]
    buffer_load_dwordx4 v[92:95], v72, s[16:19], s90 offen sc1
    v_add_f32_e64 v116, v116, abs(v116)
    v_mfma_f32_16x16x32_bf16 v[120:123], v[44:47], a[100:103], v[120:123]
    v_add_f32_e64 v117, v117, abs(v117)
    v_add_f32_e64 v118, v118, abs(v118)
    v_add_f32_e64 v119, v119, abs(v119)
    v_mfma_f32_16x16x32_bf16 v[112:115], v[48:51], a[104:107], v[112:115]
    buffer_load_dwordx4 v[96:99], v72, s[16:19], s91 offen sc1
    v_add_f32 v60, v60, v21
    v_mfma_f32_16x16x32_bf16 v[120:123], v[48:51], a[108:111], v[120:123]
    v_add_f32 v61, v61, v21
    v_add_f32 v62, v62, v21
    v_add_f32 v63, v63, v21
    v_mfma_f32_16x16x32_bf16 v[112:115], v[52:55], a[112:115], v[112:115]
    buffer_load_dwordx4 v[100:103], v72, s[16:19], s92 offen sc1
    v_fma_f32 v116, v116, 0.5, v60
    v_mfma_f32_16x16x32_bf16 v[120:123], v[52:55], a[116:119], v[120:123]
    v_fma_f32 v117, v117, 0.5, v61
    v_fma_f32 v118, v118, 0.5, v62
    v_fma_f32 v119, v119, 0.5, v63
    v_mfma_f32_16x16x32_bf16 v[112:115], v[56:59], a[120:123], v[112:115]
    buffer_load_dwordx4 v[104:107], v72, s[16:19], s93 offen sc1
    v_cvt_pk_bf16_f32 v108, v108, v109
    v_mfma_f32_16x16x32_bf16 v[120:123], v[56:59], a[124:127], v[120:123]
    v_cvt_pk_bf16_f32 v109, v110, v111
    v_cvt_pk_bf16_f32 v116, v116, v117
    v_cvt_pk_bf16_f32 v117, v118, v119
    s_barrier
    v_mov_b32 v26, s40
    s_mov_b32 s43, 0
    s_waitcnt vmcnt(0)
A_POLL_3:
    v_xor_b32 v28, v79, v26
    v_xor_b32 v29, v83, v26
    v_xor_b32 v30, v87, v26
    v_xor_b32 v31, v91, v26
    v_xor_b32 v32, v95, v26
    v_xor_b32 v33, v99, v26
    v_xor_b32 v34, v103, v26
    v_xor_b32 v35, v107, v26
    v_or3_b32 v28, v28, v29, v30
    v_or3_b32 v31, v31, v32, v33
    v_or3_b32 v28, v28, v34, v35
    v_or_b32 v28, v28, v31
    v_cmp_ne_u32 vcc, 0, v28
    s_nop 3
    s_cbranch_vccz A_GOT_4
    s_add_u32 s43, s43, 1
    s_cmp_ge_u32 s43, 131072
    s_cbranch_scc1 A_GOT_4
    s_sleep 1
    buffer_load_dwordx4 v[76:79], v72, s[16:19], s86 offen sc1
    buffer_load_dwordx4 v[80:83], v72, s[16:19], s87 offen sc1
    buffer_load_dwordx4 v[84:87], v72, s[16:19], s88 offen sc1
    buffer_load_dwordx4 v[88:91], v72, s[16:19], s89 offen sc1
    buffer_load_dwordx4 v[92:95], v72, s[16:19], s90 offen sc1
    buffer_load_dwordx4 v[96:99], v72, s[16:19], s91 offen sc1
    buffer_load_dwordx4 v[100:103], v72, s[16:19], s92 offen sc1
    buffer_load_dwordx4 v[104:107], v72, s[16:19], s93 offen sc1
    s_waitcnt vmcnt(0)
    s_branch A_POLL_3
A_GOT_4:
    v_lshlrev_b32 v28, 16, v76
    v_and_b32 v29, 0xffff0000, v76
    v_lshlrev_b32 v30, 16, v77
    v_and_b32 v31, 0xffff0000, v77
    v_lshlrev_b32 v32, 16, v80
    v_and_b32 v33, 0xffff0000, v80
    v_lshlrev_b32 v34, 16, v81
    v_and_b32 v35, 0xffff0000, v81
    v_lshlrev_b32 v52, 16, v84
    v_and_b32 v53, 0xffff0000, v84
    v_lshlrev_b32 v54, 16, v85
    v_and_b32 v55, 0xffff0000, v85
    v_add_f32 v28, v28, v52
    v_add_f32 v29, v29, v53
    v_add_f32 v30, v30, v54
    v_add_f32 v31, v31, v55
    v_lshlrev_b32 v56, 16, v88
    v_and_b32 v57, 0xffff0000, v88
    v_lshlrev_b32 v58, 16, v89
    v_and_b32 v59, 0xffff0000, v89
    v_add_f32 v32, v32, v56
    v_add_f32 v33, v33, v57
    v_add_f32 v34, v34, v58
    v_add_f32 v35, v35, v59
    v_lshlrev_b32 v52, 16, v92
    v_and_b32 v53, 0xffff0000, v92
    v_lshlrev_b32 v54, 16, v93
    v_and_b32 v55, 0xffff0000, v93
    v_add_f32 v28, v28, v52
    v_add_f32 v29, v29, v53
    v_add_f32 v30, v30, v54
    v_add_f32 v31, v31, v55
    v_lshlrev_b32 v56, 16, v96
    v_and_b32 v57, 0xffff0000, v96
    v_lshlrev_b32 v58, 16, v97
    v_and_b32 v59, 0xffff0000, v97
    v_add_f32 v32, v32, v56
    v_add_f32 v33, v33, v57
    v_add_f32 v34, v34, v58
    v_add_f32 v35, v35, v59
    v_lshlrev_b32 v52, 16, v100
    v_and_b32 v53, 0xffff0000, v100
    v_lshlrev_b32 v54, 16, v101
    v_and_b32 v55, 0xffff0000, v101
    v_add_f32 v28, v28, v52
    v_add_f32 v29, v29, v53
    v_add_f32 v30, v30, v54
    v_add_f32 v31, v31, v55
    v_lshlrev_b32 v56, 16, v104
    v_and_b32 v57, 0xffff0000, v104
    v_lshlrev_b32 v58, 16, v105
    v_and_b32 v59, 0xffff0000, v105
    v_add_f32 v32, v32, v56
    v_add_f32 v33, v33, v57
    v_add_f32 v34, v34, v58
    v_add_f32 v35, v35, v59
    v_add_f32 v28, v28, v32
    v_add_f32 v29, v29, v33
    v_add_f32 v30, v30, v34
    v_add_f32 v31, v31, v35
    v_add_f32 v36, v78, v82
    v_add_f32 v37, v86, v90
    v_add_f32 v38, v94, v98
    v_add_f32 v39, v102, v106
    v_add_f32 v36, v36, v37
    v_add_f32 v38, v38, v39
    v_add_f32 v36, v36, v38
    ds_write_b128 v68, v[28:31]
    ds_write_b32 v69, v36
    v_mul_f32 v40, v112, v20
    v_mul_f32 v41, v113, v20
    v_mul_f32 v42, v114, v20
    v_mul_f32 v43, v115, v20
    v_mul_f32 v44, v120, v20
    v_mul_f32 v45, v121, v20
    v_mul_f32 v46, v122, v20
    v_mul_f32 v47, v123, v20
    v_exp_f32_e64 v40, v40 clamp
    v_exp_f32_e64 v41, v41 clamp
    v_exp_f32_e64 v42, v42 clamp
    v_exp_f32_e64 v43, v43 clamp
    v_exp_f32_e64 v44, v44 clamp
    v_exp_f32_e64 v45, v45 clamp
    v_exp_f32_e64 v46, v46 clamp
    v_exp_f32_e64 v47, v47 clamp
    v_add_f32_e64 v112, v112, abs(v112)
    v_add_f32_e64 v113, v113, abs(v113)
    v_add_f32_e64 v114, v114, abs(v114)
    v_add_f32_e64 v115, v115, abs(v115)
    v_add_f32_e64 v120, v120, abs(v120)
    v_add_f32_e64 v121, v121, abs(v121)
    v_add_f32_e64 v122, v122, abs(v122)
    v_add_f32_e64 v123, v123, abs(v123)
    v_add_f32 v40, v40, v21
    v_add_f32 v41, v41, v21
    v_add_f32 v42, v42, v21
    v_add_f32 v43, v43, v21
    v_add_f32 v44, v44, v21
    v_add_f32 v45, v45, v21
    v_add_f32 v46, v46, v21
    v_add_f32 v47, v47, v21
    v_fma_f32 v112, v112, 0.5, v40
    v_fma_f32 v113, v113, 0.5, v41
    v_fma_f32 v114, v114, 0.5, v42
    v_fma_f32 v115, v115, 0.5, v43
    v_fma_f32 v120, v120, 0.5, v44
    v_fma_f32 v121, v121, 0.5, v45
    v_fma_f32 v122, v122, 0.5, v46
    v_fma_f32 v123, v123, 0.5, v47
    v_cvt_pk_bf16_f32 v112, v112, v113
    v_cvt_pk_bf16_f32 v113, v114, v115
    v_cvt_pk_bf16_f32 v120, v120, v121
    v_cvt_pk_bf16_f32 v121, v122, v123
    s_lshl_b32 s34, s25, 3
    s_lshl_b32 s35, s38, 1
    s_add_u32 s34, s34, s35
    s_lshl_b32 s34, s34, 5
    s_lshl_b32 s35, s26, 1
    s_add_u32 s34, s34, s35
    s_add_u32 s34, s34, s39
    s_add_u32 s34, s34, 0
    s_lshl_b32 s34, s34, 10
    s_add_u32 s50, s34, 1048576
    s_add_u32 s51, s50, 32768
    v_lshlrev_b32 v24, 4, v1
    s_lshl_b32 s34, s66, 9
    s_add_u32 m0, s33, 0
    s_nop 0
    buffer_load_dwordx4 v5, s[4:7], s34 offen lds
    s_lshl_b32 s34, s67, 9
    s_add_u32 m0, s33, 8192
    s_nop 0
    buffer_load_dwordx4 v5, s[4:7], s34 offen lds
    s_lshl_b32 s34, s68, 9
    s_add_u32 m0, s33, 16384
    s_nop 0
    buffer_load_dwordx4 v5, s[4:7], s34 offen lds
    s_waitcnt lgkmcnt(0)
    s_barrier
    ds_read_b128 v[92:95], v71 offset:0
    ds_read_b128 v[96:99], v71 offset:64
    ds_read_b128 v[100:103], v71 offset:128
    ds_read_b128 v[104:107], v71 offset:192
    ds_read_b128 v[76:79], v70 offset:0
    ds_read_b128 v[80:83], v70 offset:1024
    ds_read_b128 v[84:87], v70 offset:2048
    ds_read_b128 v[88:91], v70 offset:3072
    s_lshl_b32 s34, s69, 9
    s_add_u32 m0, s33, 24576
    s_nop 0
    buffer_load_dwordx4 v5, s[4:7], s34 offen lds
    s_lshl_b32 s34, s70, 9
    s_add_u32 m0, s33, 32768
    s_nop 0
    buffer_load_dwordx4 v5, s[4:7], s34 offen lds
    s_lshl_b32 s34, s71, 9
    s_add_u32 m0, s33, 40960
    s_nop 0
    buffer_load_dwordx4 v5, s[4:7], s34 offen lds
    s_waitcnt lgkmcnt(4)
    v_add_f32 v92, v92, v96
    v_add_f32 v93, v93, v97
    v_add_f32 v94, v94, v98
    v_add_f32 v95, v95, v99
    v_cvt_pk_bf16_f32 v56, v92, v93
    v_cvt_pk_bf16_f32 v57, v94, v95
    v_add_f32 v100, v100, v104
    v_add_f32 v101, v101, v105
    v_add_f32 v102, v102, v106
    v_add_f32 v103, v103, v107
    v_cvt_pk_bf16_f32 v58, v100, v101
    v_cvt_pk_bf16_f32 v59, v102, v103
    s_waitcnt lgkmcnt(0)
    v_mfma_f32_16x16x16_bf16 v[28:31], v[56:57], v[108:109], 0
    v_mfma_f32_16x16x16_bf16 v[32:35], v[58:59], v[112:113], 0
    v_mfma_f32_16x16x16_bf16 v[36:39], v[56:57], v[116:117], 0
    v_mfma_f32_16x16x16_bf16 v[40:43], v[58:59], v[120:121], 0
    v_add_f32 v76, v76, v80
    v_add_f32 v77, v77, v81
    v_add_f32 v78, v78, v82
    v_add_f32 v79, v79, v83
    v_cvt_pk_bf16_f32 v52, v76, v77
    v_cvt_pk_bf16_f32 v53, v78, v79
    v_add_f32 v84, v84, v88
    v_add_f32 v85, v85, v89
    v_add_f32 v86, v86, v90
    v_add_f32 v87, v87, v91
    v_cvt_pk_bf16_f32 v54, v84, v85
    v_cvt_pk_bf16_f32 v55, v86, v87
    v_mfma_f32_16x16x16_bf16 v[92:95], v[52:53], v[108:109], 0
    s_nop 0
    v_mfma_f32_16x16x16_bf16 v[96:99], v[54:55], v[112:113], 0
    v_mfma_f32_16x16x16_bf16 v[100:103], v[52:53], v[116:117], 0
    v_mfma_f32_16x16x16_bf16 v[104:107], v[54:55], v[120:121], 0
    s_lshl_b32 s34, s72, 9
    s_add_u32 m0, s33, 49152
    s_nop 0
    buffer_load_dwordx4 v5, s[4:7], s34 offen lds
    s_lshl_b32 s34, s73, 9
    s_add_u32 m0, s33, 57344
    s_nop 0
    buffer_load_dwordx4 v5, s[4:7], s34 offen lds
    v_add_f32 v28, v28, v21
    v_add_f32 v32, v32, v21
    v_add_f32 v36, v36, v21
    v_add_f32 v40, v40, v21
    v_rcp_f32 v28, v28
    v_rcp_f32 v32, v32
    v_rcp_f32 v36, v36
    v_rcp_f32 v40, v40
    v_mul_f32 v92, v92, v28
    v_mul_f32 v93, v93, v28
    v_mul_f32 v94, v94, v28
    v_mul_f32 v95, v95, v28
    v_cvt_pk_bf16_f32 v76, v92, v93
    v_cvt_pk_bf16_f32 v77, v94, v95
    v_mul_f32 v96, v96, v32
    v_mul_f32 v97, v97, v32
    v_mul_f32 v98, v98, v32
    v_mul_f32 v99, v99, v32
    v_cvt_pk_bf16_f32 v78, v96, v97
    v_cvt_pk_bf16_f32 v79, v98, v99
    buffer_store_dwordx4 v[76:79], v24, s[16:19], s50 offen sc1
    v_mul_f32 v100, v100, v36
    v_mul_f32 v101, v101, v36
    v_mul_f32 v102, v102, v36
    v_mul_f32 v103, v103, v36
    v_cvt_pk_bf16_f32 v80, v100, v101
    v_cvt_pk_bf16_f32 v81, v102, v103
    v_mul_f32 v104, v104, v40
    v_mul_f32 v105, v105, v40
    v_mul_f32 v106, v106, v40
    v_mul_f32 v107, v107, v40
    v_cvt_pk_bf16_f32 v82, v104, v105
    v_cvt_pk_bf16_f32 v83, v106, v107
    buffer_store_dwordx4 v[80:83], v24, s[16:19], s51 offen sc1
    s_branch L_P2
L_B:
    s_mul_i32 s32, s24, 3072
    s_add_u32 s32, s32, 18432
    s_add_u32 m0, s31, 0
    s_nop 0
    buffer_load_dwordx4 v2, s[8:11], s66 offen lds
    buffer_load_dwordx4 v3, s[8:11], s66 offen offset:1024 lds
    s_add_u32 m0, s32, 0
    s_nop 0
    buffer_load_dwordx4 v4, s[12:15], s74 offen offset:1024 lds
    buffer_load_dwordx4 v4, s[12:15], s74 offen offset:2048 lds
    s_lshl_b32 s30, s25, 7
    s_sub_u32 s30, s30, 16
    s_max_i32 s30, s30, 0
    s_lshl_b32 s34, s24, 1
    s_add_u32 s30, s30, s34
    s_lshl_b32 s30, s30, 10
    s_lshl_b32 s33, s24, 8
    s_add_u32 s33, s33, 16384
    v_lshrrev_b32 v24, 3, v1
    v_and_b32 v26, 7, v1
    v_xor_b32 v27, s24, v26
    v_lshlrev_b32 v27, 4, v27
    v_lshl_add_u32 v5, v24, 10, v27
    v_add_u32 v5, s30, v5
    s_add_u32 m0, s33, 0
    s_mov_b64 exec, 0xffff
    buffer_load_dwordx4 v5, s[8:11], s66 offen lds
    s_mov_b64 exec, -1
    s_add_u32 m0, s32, 0
    s_nop 0
    buffer_load_dwordx4 v4, s[12:15], s74 offen lds
    s_add_u32 s67, s66, 128
    s_and_b32 s67, s67, 1023
    s_mul_i32 s75, s67, 1536
    s_barrier
    s_add_u32 m0, s31, 43008
    s_nop 0
    buffer_load_dwordx4 v2, s[8:11], s67 offen lds
    buffer_load_dwordx4 v3, s[8:11], s67 offen offset:1024 lds
    s_add_u32 m0, s32, 43008
    s_nop 0
    buffer_load_dwordx4 v4, s[12:15], s75 offen offset:1024 lds
    buffer_load_dwordx4 v4, s[12:15], s75 offen offset:2048 lds
    s_add_u32 m0, s33, 43008
    s_mov_b64 exec, 0xffff
    buffer_load_dwordx4 v5, s[8:11], s67 offen lds
    s_mov_b64 exec, -1
    s_add_u32 m0, s32, 43008
    s_nop 0
    buffer_load_dwordx4 v4, s[12:15], s75 offen lds
    v_and_b32 v24, 15, v1
    v_lshrrev_b32 v25, 4, v1
    v_lshrrev_b32 v26, 1, v24
    v_xor_b32 v26, v26, v25
    v_lshlrev_b32 v26, 4, v26
    v_lshl_add_u32 v26, v24, 7, v26
    s_lshl_b32 s34, s38, 12
    v_add_u32 v6, s34, v26
    v_xor_b32 v7, 64, v6
    v_add_u32 v28, 16384, v26
    v_xor_b32 v29, 64, v28
    v_lshrrev_b32 v26, 2, v24
    v_lshrrev_b32 v27, 1, v26
    v_and_b32 v20, 1, v25
    v_lshl_or_b32 v27, v20, 1, v27
    s_lshl_b32 s34, s39, 1
    v_xor_b32 v27, s34, v27
    v_lshlrev_b32 v27, 5, v27
    v_lshl_add_u32 v27, v26, 7, v27
    v_mul_u32_u24 v25, 3072, v25
    v_add_u32 v27, v27, v25
    v_and_b32 v20, 3, v1
    v_lshl_add_u32 v27, v20, 3, v27
    v_add_u32 v12, 18432, v27
    v_xor_b32 v13, 32, v12
    s_and_b32 s34, s38, 1
    s_lshl_b32 s34, s34, 5
    s_lshr_b32 s35, s38, 1
    s_lshl_b32 s35, s35, 10
    s_add_u32 s35, s35, 1024
    v_xor_b32 v34, s34, v12
    v_add_u32 v34, s35, v34
    s_add_u32 s68, s67, 128
    s_and_b32 s68, s68, 1023
    s_mul_i32 s76, s68, 1536
    s_waitcnt vmcnt(6)
    s_barrier
    ds_read_b128 a[0:3], v6 offset:0
    ds_read_b64_tr_b16 a[20:21], v12 offset:1024
    ds_read_b64_tr_b16 a[22:23], v12 offset:1536
    ds_read_b128 a[4:7], v6 offset:2048
    ds_read_b64_tr_b16 a[24:25], v13 offset:1024
    ds_read_b64_tr_b16 a[26:27], v13 offset:1536
    ds_read_b64_tr_b16 a[28:29], v12 offset:2048
    ds_read_b64_tr_b16 a[30:31], v12 offset:2560
    ds_read_b64_tr_b16 a[32:33], v13 offset:2048
    ds_read_b64_tr_b16 a[34:35], v13 offset:2560
    ds_read_b64_tr_b16 a[12:13], v12 offset:0
    ds_read_b64_tr_b16 a[14:15], v12 offset:512
    ds_read_b64_tr_b16 a[16:17], v13 offset:0
    ds_read_b64_tr_b16 a[18:19], v13 offset:512
    ds_read_b128 a[8:11], v28
    ds_read_b64_tr_b16 a[36:37], v34 offset:0
    ds_read_b64_tr_b16 a[38:39], v34 offset:512
    s_waitcnt lgkmcnt(0)
    v_add_u32 v8, 43008, v6
    v_add_u32 v14, 43008, v12
    v_add_u32 v30, 43008, v28
    v_add_u32 v9, 43008, v7
    v_add_u32 v15, 43008, v13
    v_add_u32 v31, 43008, v29
    v_add_u32 v35, 43008, v34
    v_add_u32 v10, 86016, v6
    v_add_u32 v16, 86016, v12
    v_add_u32 v32, 86016, v28
    v_add_u32 v11, 86016, v7
    v_add_u32 v17, 86016, v13
    v_add_u32 v33, 86016, v29
    v_add_u32 v36, 86016, v34
    v_mfma_f32_16x16x32_bf16 v[76:79], a[20:23], a[0:3], 0
    ds_read_b128 a[64:67], v7 offset:0
    ds_read_b64_tr_b16 a[84:85], v12 offset:13312
    s_add_u32 s69, s68, 128
    v_mfma_f32_16x16x32_bf16 v[84:87], a[20:23], a[4:7], 0
    ds_read_b64_tr_b16 a[86:87], v12 offset:13824
    ds_read_b128 a[68:71], v7 offset:2048
    s_and_b32 s69, s69, 1023
    v_mfma_f32_16x16x32_bf16 v[80:83], a[24:27], a[0:3], 0
    ds_read_b64_tr_b16 a[88:89], v13 offset:13312
    ds_read_b64_tr_b16 a[90:91], v13 offset:13824
    s_mul_i32 s77, s69, 1536
    v_mfma_f32_16x16x32_bf16 v[88:91], a[24:27], a[4:7], 0
    ds_read_b64_tr_b16 a[92:93], v12 offset:14336
    ds_read_b64_tr_b16 a[94:95], v12 offset:14848
    s_add_u32 s70, s69, 128
    v_mfma_f32_16x16x32_bf16 v[92:95], a[0:3], a[28:31], 0
    ds_read_b64_tr_b16 a[96:97], v13 offset:14336
    ds_read_b64_tr_b16 a[98:99], v13 offset:14848
    s_and_b32 s70, s70, 1023
    v_mfma_f32_16x16x32_bf16 v[100:103], a[4:7], a[28:31], 0
    ds_read_b64_tr_b16 a[76:77], v12 offset:12288
    ds_read_b64_tr_b16 a[78:79], v12 offset:12800
    s_mul_i32 s78, s70, 1536
    v_mfma_f32_16x16x32_bf16 v[96:99], a[0:3], a[32:35], 0
    ds_read_b64_tr_b16 a[80:81], v13 offset:12288
    ds_read_b64_tr_b16 a[82:83], v13 offset:12800
    s_add_u32 s71, s70, 128
    v_mfma_f32_16x16x32_bf16 v[104:107], a[4:7], a[32:35], 0
    ds_read_b128 a[72:75], v29
    ds_read_b64_tr_b16 a[100:101], v34 offset:12288
    s_and_b32 s71, s71, 1023
    v_mfma_f32_16x16x32_bf16 v[108:111], a[12:15], a[0:3], 0
    ds_read_b64_tr_b16 a[102:103], v34 offset:12800
    s_mul_i32 s79, s71, 1536
    s_add_u32 s72, s71, 128
    s_and_b32 s72, s72, 1023
    s_mul_i32 s80, s72, 1536
    v_mfma_f32_16x16x32_bf16 v[116:119], a[12:15], a[4:7], 0
    s_add_u32 m0, s31, 86016
    s_nop 0
    buffer_load_dwordx4 v2, s[8:11], s68 offen lds
    buffer_load_dwordx4 v3, s[8:11], s68 offen offset:1024 lds
    s_add_u32 s73, s72, 128
    s_and_b32 s73, s73, 1023
    v_mfma_f32_16x16x32_bf16 v[112:115], a[16:19], a[0:3], 0
    s_add_u32 m0, s32, 86016
    s_nop 0
    buffer_load_dwordx4 v4, s[12:15], s76 offen offset:1024 lds
    buffer_load_dwordx4 v4, s[12:15], s76 offen offset:2048 lds
    s_mul_i32 s81, s73, 1536
    s_mov_b32 s58, s62
    v_mfma_f32_16x16x32_bf16 v[120:123], a[16:19], a[4:7], 0
    s_add_u32 m0, s33, 86016
    s_mov_b64 exec, 0xffff
    buffer_load_dwordx4 v5, s[8:11], s68 offen lds
    s_mov_b64 exec, -1
    s_mov_b32 s59, s63
    s_mov_b32 s62, 2097152
    v_mfma_f32_16x16x32_bf16 v[124:127], a[8:11], a[36:39], 0
    s_add_u32 m0, s32, 86016
    s_nop 0
    buffer_load_dwordx4 v4, s[12:15], s76 offen lds
    s_mov_b32 s63, 0x20000
    s_mov_b32 s16, s56
    s_waitcnt vmcnt(6) lgkmcnt(0)
    s_barrier
    v_mfma_f32_16x16x32_bf16 v[76:79], a[84:87], a[64:67], v[76:79]
    ds_read_b128 a[0:3], v8 offset:0
    ds_read_b64_tr_b16 a[20:21], v14 offset:1024
    s_mov_b32 s17, s57
    v_mfma_f32_16x16x32_bf16 v[84:87], a[84:87], a[68:71], v[84:87]
    ds_read_b64_tr_b16 a[22:23], v14 offset:1536
    ds_read_b128 a[4:7], v8 offset:2048
    s_mov_b32 s18, 268435456
    v_mfma_f32_16x16x32_bf16 v[80:83], a[88:91], a[64:67], v[80:83]
    ds_read_b64_tr_b16 a[24:25], v15 offset:1024
    ds_read_b64_tr_b16 a[26:27], v15 offset:1536
    s_mov_b32 s19, 0x20000
    v_mfma_f32_16x16x32_bf16 v[88:91], a[88:91], a[68:71], v[88:91]
    ds_read_b64_tr_b16 a[28:29], v14 offset:2048
    ds_read_b64_tr_b16 a[30:31], v14 offset:2560
    s_or_b32 s34, s2, s24
    s_cmp_lg_u32 s34, 0
    s_cbranch_scc1 NONCE_1003
    s_memrealtime s[44:45]
    s_waitcnt lgkmcnt(0)
    s_mul_i32 s44, s44, 0x9E3779B1
    s_or_b32 s44, s44, 1
    v_mov_b32 v24, s44
    v_mov_b32 v25, 0
    s_mov_b64 exec, 1
    global_store_dword v25, v24, s[58:59] sc1
    s_mov_b64 exec, -1
NONCE_1003:
    s_nop 0
    v_mfma_f32_16x16x32_bf16 v[92:95], a[64:67], a[92:95], v[92:95]
    ds_read_b64_tr_b16 a[32:33], v15 offset:2048
    ds_read_b64_tr_b16 a[34:35], v15 offset:2560
    s_and_b32 s34, s2, 7
    v_mfma_f32_16x16x32_bf16 v[100:103], a[68:71], a[92:95], v[100:103]
    ds_read_b64_tr_b16 a[12:13], v14 offset:0
    ds_read_b64_tr_b16 a[14:15], v14 offset:512
    s_lshr_b32 s35, s2, 3
    v_mfma_f32_16x16x32_bf16 v[96:99], a[64:67], a[96:99], v[96:99]
    ds_read_b64_tr_b16 a[16:17], v15 offset:0
    ds_read_b64_tr_b16 a[18:19], v15 offset:512
    s_lshr_b32 s54, s34, 1
    v_mfma_f32_16x16x32_bf16 v[104:107], a[68:71], a[96:99], v[104:107]
    ds_read_b128 a[8:11], v30
    ds_read_b64_tr_b16 a[36:37], v35 offset:0
    s_lshl_b32 s54, s54, 3
    v_mfma_f32_16x16x32_bf16 v[108:111], a[76:79], a[64:67], v[108:111]
    ds_read_b64_tr_b16 a[38:39], v35 offset:512
    s_and_b32 s36, s35, 7
    s_add_u32 s54, s54, s36
    s_lshr_b32 s37, s35, 3
    s_and_b32 s55, s34, 1
    v_mfma_f32_16x16x32_bf16 v[116:119], a[76:79], a[68:71], v[116:119]
    s_add_u32 m0, s31, 0
    s_nop 0
    buffer_load_dwordx4 v2, s[8:11], s69 offen lds
    buffer_load_dwordx4 v3, s[8:11], s69 offen offset:1024 lds
    s_lshl_b32 s55, s55, 2
    s_add_u32 s55, s55, s37
    v_mfma_f32_16x16x32_bf16 v[112:115], a[80:83], a[64:67], v[112:115]
    s_lshl_b32 s65, s24, 13
    s_lshl_b32 s34, s55, 7
    s_add_u32 s65, s65, s34
    s_mov_b32 s20, s84
    v_mfma_f32_16x16x32_bf16 v[120:123], a[80:83], a[68:71], v[120:123]
    s_add_u32 m0, s32, 0
    s_nop 0
    buffer_load_dwordx4 v4, s[12:15], s77 offen offset:1024 lds
    buffer_load_dwordx4 v4, s[12:15], s77 offen offset:2048 lds
    s_mov_b32 s21, s85
    s_mov_b32 s22, 524288
    v_mfma_f32_16x16x32_bf16 v[124:127], a[72:75], a[100:103], v[124:127]
    s_mov_b32 s23, 0x20000
    s_mov_b32 s4, s82
    s_mov_b32 s5, s83
    s_mov_b32 s6, 524288
    s_waitcnt lgkmcnt(0)
    v_mfma_f32_16x16x32_bf16 v[76:79], a[20:23], a[0:3], v[76:79]
    ds_read_b128 a[64:67], v9 offset:0
    ds_read_b64_tr_b16 a[84:85], v14 offset:13312
    s_mov_b32 s7, 0x20000
    v_mfma_f32_16x16x32_bf16 v[84:87], a[20:23], a[4:7], v[84:87]
    ds_read_b64_tr_b16 a[86:87], v14 offset:13824
    ds_read_b128 a[68:71], v9 offset:2048
    v_and_b32 v24, 15, v1
    v_mfma_f32_16x16x32_bf16 v[80:83], a[24:27], a[0:3], v[80:83]
    ds_read_b64_tr_b16 a[88:89], v15 offset:13312
    ds_read_b64_tr_b16 a[90:91], v15 offset:13824
    v_lshrrev_b32 v25, 4, v1
    v_mfma_f32_16x16x32_bf16 v[88:91], a[24:27], a[4:7], v[88:91]
    ds_read_b64_tr_b16 a[92:93], v14 offset:14336
    ds_read_b64_tr_b16 a[94:95], v14 offset:14848
    v_lshlrev_b32 v25, 2, v25
    v_mfma_f32_16x16x32_bf16 v[92:95], a[0:3], a[28:31], v[92:95]
    ds_read_b64_tr_b16 a[96:97], v15 offset:14336
    ds_read_b64_tr_b16 a[98:99], v15 offset:14848
    v_sub_u32 v24, v24, v25
    v_mfma_f32_16x16x32_bf16 v[100:103], a[4:7], a[28:31], v[100:103]
    ds_read_b64_tr_b16 a[76:77], v14 offset:12288
    ds_read_b64_tr_b16 a[78:79], v14 offset:12800
    v_mov_b32 v27, 0xcf6e6b28
    v_mfma_f32_16x16x32_bf16 v[96:99], a[0:3], a[32:35], v[96:99]
    ds_read_b64_tr_b16 a[80:81], v15 offset:12288
    ds_read_b64_tr_b16 a[82:83], v15 offset:12800
    s_or_b32 s34, s25, s38
    v_mfma_f32_16x16x32_bf16 v[104:107], a[4:7], a[32:35], v[104:107]
    ds_read_b128 a[72:75], v31
    ds_read_b64_tr_b16 a[100:101], v35 offset:12288
    s_cmp_eq_u32 s34, 0
    v_mfma_f32_16x16x32_bf16 v[108:111], a[12:15], a[0:3], v[108:111]
    ds_read_b64_tr_b16 a[102:103], v35 offset:12800
    s_cselect_b64 s[48:49], 0, -1
    v_subrev_u32 v25, 0, v24
    v_and_b32 v26, 1, v25
    v_cmp_eq_u32 s[44:45], 0, v26
    v_mfma_f32_16x16x32_bf16 v[116:119], a[12:15], a[4:7], v[116:119]
    s_add_u32 m0, s33, 0
    s_mov_b64 exec, 0xffff
    buffer_load_dwordx4 v5, s[8:11], s69 offen lds
    s_mov_b64 exec, -1
    v_cmp_le_i32 s[46:47], 0, v25
    s_nop 3
    s_and_b64 s[46:47], s[46:47], s[44:45]
    v_mfma_f32_16x16x32_bf16 v[112:115], a[16:19], a[0:3], v[112:115]
    v_cndmask_b32 v40, v27, 0, s[46:47]
    v_cmp_ge_i32 s[46:47], -2, v25
    s_nop 3
    s_and_b64 s[46:47], s[46:47], s[44:45]
    v_cndmask_b32 v44, v27, 0, s[46:47]
    v_mfma_f32_16x16x32_bf16 v[120:123], a[16:19], a[4:7], v[120:123]
    s_add_u32 m0, s32, 0
    s_nop 0
    buffer_load_dwordx4 v4, s[12:15], s77 offen lds
    s_and_b64 s[46:47], s[46:47], s[48:49]
    v_cndmask_b32 v48, v27, 0, s[46:47]
    v_mfma_f32_16x16x32_bf16 v[124:127], a[8:11], a[36:39], v[124:127]
    v_subrev_u32 v25, 1, v24
    v_and_b32 v26, 1, v25
    v_cmp_eq_u32 s[44:45], 0, v26
    v_cmp_le_i32 s[46:47], 0, v25
    s_waitcnt vmcnt(6) lgkmcnt(0)
    s_barrier
    v_mfma_f32_16x16x32_bf16 v[76:79], a[84:87], a[64:67], v[76:79]
    ds_read_b128 a[0:3], v10 offset:0
    ds_read_b64_tr_b16 a[20:21], v16 offset:1024
    s_and_b64 s[46:47], s[46:47], s[44:45]
    v_mfma_f32_16x16x32_bf16 v[84:87], a[84:87], a[68:71], v[84:87]
    ds_read_b64_tr_b16 a[22:23], v16 offset:1536
    ds_read_b128 a[4:7], v10 offset:2048
    v_cndmask_b32 v41, v27, 0, s[46:47]
    v_mfma_f32_16x16x32_bf16 v[80:83], a[88:91], a[64:67], v[80:83]
    ds_read_b64_tr_b16 a[24:25], v17 offset:1024
    ds_read_b64_tr_b16 a[26:27], v17 offset:1536
    v_cmp_ge_i32 s[46:47], -2, v25
    v_mfma_f32_16x16x32_bf16 v[88:91], a[88:91], a[68:71], v[88:91]
    ds_read_b64_tr_b16 a[28:29], v16 offset:2048
    ds_read_b64_tr_b16 a[30:31], v16 offset:2560
    s_nop 0
    s_and_b64 s[46:47], s[46:47], s[44:45]
    v_mfma_f32_16x16x32_bf16 v[92:95], a[64:67], a[92:95], v[92:95]
    ds_read_b64_tr_b16 a[32:33], v17 offset:2048
    ds_read_b64_tr_b16 a[34:35], v17 offset:2560
    v_cndmask_b32 v45, v27, 0, s[46:47]
    v_mfma_f32_16x16x32_bf16 v[100:103], a[68:71], a[92:95], v[100:103]
    ds_read_b64_tr_b16 a[12:13], v16 offset:0
    ds_read_b64_tr_b16 a[14:15], v16 offset:512
    s_and_b64 s[46:47], s[46:47], s[48:49]
    v_mfma_f32_16x16x32_bf16 v[96:99], a[64:67], a[96:99], v[96:99]
    ds_read_b64_tr_b16 a[16:17], v17 offset:0
    ds_read_b64_tr_b16 a[18:19], v17 offset:512
    v_cndmask_b32 v49, v27, 0, s[46:47]
    v_mfma_f32_16x16x32_bf16 v[104:107], a[68:71], a[96:99], v[104:107]
    ds_read_b128 a[8:11], v32
    ds_read_b64_tr_b16 a[36:37], v36 offset:0
    v_subrev_u32 v25, 2, v24
    v_mfma_f32_16x16x32_bf16 v[108:111], a[76:79], a[64:67], v[108:111]
    ds_read_b64_tr_b16 a[38:39], v36 offset:512
    v_and_b32 v26, 1, v25
    v_cmp_eq_u32 s[44:45], 0, v26
    v_cmp_le_i32 s[46:47], 0, v25
    s_nop 3
    s_and_b64 s[46:47], s[46:47], s[44:45]
    v_mfma_f32_16x16x32_bf16 v[116:119], a[76:79], a[68:71], v[116:119]
    s_add_u32 m0, s31, 43008
    s_nop 0
    buffer_load_dwordx4 v2, s[8:11], s70 offen lds
    buffer_load_dwordx4 v3, s[8:11], s70 offen offset:1024 lds
    v_cndmask_b32 v42, v27, 0, s[46:47]
    v_cmp_ge_i32 s[46:47], -2, v25
    v_mfma_f32_16x16x32_bf16 v[112:115], a[80:83], a[64:67], v[112:115]
    s_nop 2
    s_and_b64 s[46:47], s[46:47], s[44:45]
    v_cndmask_b32 v46, v27, 0, s[46:47]
    s_and_b64 s[46:47], s[46:47], s[48:49]
    v_cndmask_b32 v50, v27, 0, s[46:47]
    v_mfma_f32_16x16x32_bf16 v[120:123], a[80:83], a[68:71], v[120:123]
    s_add_u32 m0, s32, 43008
    s_nop 0
    buffer_load_dwordx4 v4, s[12:15], s78 offen offset:1024 lds
    buffer_load_dwordx4 v4, s[12:15], s78 offen offset:2048 lds
    v_subrev_u32 v25, 3, v24
    v_and_b32 v26, 1, v25
    v_mfma_f32_16x16x32_bf16 v[124:127], a[72:75], a[100:103], v[124:127]
    v_cmp_eq_u32 s[44:45], 0, v26
    v_cmp_le_i32 s[46:47], 0, v25
    s_nop 3
    s_and_b64 s[46:47], s[46:47], s[44:45]
    v_cndmask_b32 v43, v27, 0, s[46:47]
    s_waitcnt lgkmcnt(0)
    v_mfma_f32_16x16x32_bf16 v[76:79], a[20:23], a[0:3], v[76:79]
    ds_read_b128 a[64:67], v11 offset:0
    ds_read_b64_tr_b16 a[84:85], v16 offset:13312
    v_cmp_ge_i32 s[46:47], -2, v25
    v_mfma_f32_16x16x32_bf16 v[84:87], a[20:23], a[4:7], v[84:87]
    ds_read_b64_tr_b16 a[86:87], v16 offset:13824
    ds_read_b128 a[68:71], v11 offset:2048
    s_nop 0
    s_and_b64 s[46:47], s[46:47], s[44:45]
    v_mfma_f32_16x16x32_bf16 v[80:83], a[24:27], a[0:3], v[80:83]
    ds_read_b64_tr_b16 a[88:89], v17 offset:13312
    ds_read_b64_tr_b16 a[90:91], v17 offset:13824
    v_cndmask_b32 v47, v27, 0, s[46:47]
    v_mfma_f32_16x16x32_bf16 v[88:91], a[24:27], a[4:7], v[88:91]
    ds_read_b64_tr_b16 a[92:93], v16 offset:14336
    ds_read_b64_tr_b16 a[94:95], v16 offset:14848
    s_and_b64 s[46:47], s[46:47], s[48:49]
    v_mfma_f32_16x16x32_bf16 v[92:95], a[0:3], a[28:31], v[92:95]
    ds_read_b64_tr_b16 a[96:97], v17 offset:14336
    ds_read_b64_tr_b16 a[98:99], v17 offset:14848
    v_cndmask_b32 v51, v27, 0, s[46:47]
    v_mfma_f32_16x16x32_bf16 v[100:103], a[4:7], a[28:31], v[100:103]
    ds_read_b64_tr_b16 a[76:77], v16 offset:12288
    ds_read_b64_tr_b16 a[78:79], v16 offset:12800
    v_mov_b32 v52, 0x3f803f80
    v_mfma_f32_16x16x32_bf16 v[96:99], a[0:3], a[32:35], v[96:99]
    ds_read_b64_tr_b16 a[80:81], v17 offset:12288
    ds_read_b64_tr_b16 a[82:83], v17 offset:12800
    v_mov_b32 v53, 0x3f803f80
    v_mfma_f32_16x16x32_bf16 v[104:107], a[4:7], a[32:35], v[104:107]
    ds_read_b128 a[72:75], v33
    ds_read_b64_tr_b16 a[100:101], v36 offset:12288
    v_mov_b32 v54, 0x3f803f80
    v_mfma_f32_16x16x32_bf16 v[108:111], a[12:15], a[0:3], v[108:111]
    ds_read_b64_tr_b16 a[102:103], v36 offset:12800
    v_mov_b32 v55, 0x3f803f80
    s_lshl_b32 s34, s39, 2
    s_add_u32 s34, s34, s38
    s_lshl_b32 s34, s34, 11
    v_mfma_f32_16x16x32_bf16 v[116:119], a[12:15], a[4:7], v[116:119]
    s_add_u32 m0, s33, 43008
    s_mov_b64 exec, 0xffff
    buffer_load_dwordx4 v5, s[8:11], s70 offen lds
    s_mov_b64 exec, -1
    s_add_u32 s34, s34, 140288
    v_lshl_add_u32 v56, v1, 3, s34
    v_mfma_f32_16x16x32_bf16 v[112:115], a[16:19], a[0:3], v[112:115]
    s_lshl_b32 s34, s39, 13
    s_and_b32 s35, s38, 1
    s_lshl_b32 s35, s35, 10
    s_add_u32 s34, s34, s35
    v_mfma_f32_16x16x32_bf16 v[120:123], a[16:19], a[4:7], v[120:123]
    s_add_u32 m0, s32, 43008
    s_nop 0
    buffer_load_dwordx4 v4, s[12:15], s78 offen lds
    s_add_u32 s34, s34, 140288
    v_and_b32 v25, 15, v1
    v_mfma_f32_16x16x32_bf16 v[124:127], a[8:11], a[36:39], v[124:127]
    v_lshrrev_b32 v26, 2, v25
    v_lshlrev_b32 v26, 7, v26
    v_lshrrev_b32 v27, 4, v1
    v_lshl_add_u32 v26, v27, 5, v26
    s_waitcnt vmcnt(6) lgkmcnt(0)
    s_barrier
    v_mfma_f32_16x16x32_bf16 v[76:79], a[84:87], a[64:67], v[76:79]
    ds_read_b128 a[0:3], v6 offset:0
    ds_read_b64_tr_b16 a[20:21], v12 offset:1024
    v_and_b32 v25, 3, v25
    v_mfma_f32_16x16x32_bf16 v[84:87], a[84:87], a[68:71], v[84:87]
    ds_read_b64_tr_b16 a[22:23], v12 offset:1536
    ds_read_b128 a[4:7], v6 offset:2048
    v_lshl_add_u32 v26, v25, 1, v26
    v_mfma_f32_16x16x32_bf16 v[80:83], a[88:91], a[64:67], v[80:83]
    ds_read_b64_tr_b16 a[24:25], v13 offset:1024
    ds_read_b64_tr_b16 a[26:27], v13 offset:1536
    v_add_u32 v26, s34, v26
    v_mfma_f32_16x16x32_bf16 v[88:91], a[88:91], a[68:71], v[88:91]
    ds_read_b64_tr_b16 a[28:29], v12 offset:2048
    ds_read_b64_tr_b16 a[30:31], v12 offset:2560
    v_lshl_add_u32 v27, v1, 3, s34
    v_mfma_f32_16x16x32_bf16 v[92:95], a[64:67], a[92:95], v[92:95]
    ds_read_b64_tr_b16 a[32:33], v13 offset:2048
    ds_read_b64_tr_b16 a[34:35], v13 offset:2560
    v_add_u32 v27, 512, v27
    v_mfma_f32_16x16x32_bf16 v[100:103], a[68:71], a[92:95], v[100:103]
    ds_read_b64_tr_b16 a[12:13], v12 offset:0
    ds_read_b64_tr_b16 a[14:15], v12 offset:512
    s_cmp_ge_u32 s38, 2
    v_mfma_f32_16x16x32_bf16 v[96:99], a[64:67], a[96:99], v[96:99]
    ds_read_b64_tr_b16 a[16:17], v13 offset:0
    ds_read_b64_tr_b16 a[18:19], v13 offset:512
    s_cselect_b64 s[46:47], -1, 0
    v_mfma_f32_16x16x32_bf16 v[104:107], a[68:71], a[96:99], v[104:107]
    ds_read_b128 a[8:11], v28
    ds_read_b64_tr_b16 a[36:37], v34 offset:0
    v_cndmask_b32 v57, v26, v27, s[46:47]
    v_mfma_f32_16x16x32_bf16 v[108:111], a[76:79], a[64:67], v[108:111]
    ds_read_b64_tr_b16 a[38:39], v34 offset:512
    v_mov_b32 v20, 0x3eb8aa3b
    v_mov_b32 v37, 163776
    v_mov_b32 v38, 0
    v_mov_b32 v39, 0
    ds_write_b64 v37, v[38:39]
    ds_write_b64 v37, v[38:39] offset:8
    v_mfma_f32_16x16x32_bf16 v[116:119], a[76:79], a[68:71], v[116:119]
    v_mov_b32 v37, 0
    global_load_dword v22, v37, s[58:59] sc1
    v_mfma_f32_16x16x32_bf16 v[112:115], a[80:83], a[64:67], v[112:115]
    v_mfma_f32_16x16x32_bf16 v[120:123], a[80:83], a[68:71], v[120:123]
    s_add_u32 m0, s31, 86016
    s_nop 0
    buffer_load_dwordx4 v2, s[8:11], s71 offen lds
    buffer_load_dwordx4 v3, s[8:11], s71 offen offset:1024 lds
    v_mfma_f32_16x16x32_bf16 v[124:127], a[72:75], a[100:103], v[124:127]
    s_waitcnt lgkmcnt(0)
    v_mfma_f32_16x16x32_bf16 v[76:79], a[20:23], a[0:3], v[76:79]
    ds_read_b128 a[64:67], v7 offset:0
    ds_read_b64_tr_b16 a[84:85], v12 offset:13312
    v_mfma_f32_16x16x32_bf16 v[84:87], a[20:23], a[4:7], v[84:87]
    ds_read_b64_tr_b16 a[86:87], v12 offset:13824
    ds_read_b128 a[68:71], v7 offset:2048
    v_mfma_f32_16x16x32_bf16 v[80:83], a[24:27], a[0:3], v[80:83]
    ds_read_b64_tr_b16 a[88:89], v13 offset:13312
    ds_read_b64_tr_b16 a[90:91], v13 offset:13824
    v_mfma_f32_16x16x32_bf16 v[88:91], a[24:27], a[4:7], v[88:91]
    ds_read_b64_tr_b16 a[92:93], v12 offset:14336
    ds_read_b64_tr_b16 a[94:95], v12 offset:14848
    v_mfma_f32_16x16x32_bf16 v[92:95], a[0:3], a[28:31], v[92:95]
    ds_read_b64_tr_b16 a[96:97], v13 offset:14336
    ds_read_b64_tr_b16 a[98:99], v13 offset:14848
    v_mfma_f32_16x16x32_bf16 v[100:103], a[4:7], a[28:31], v[100:103]
    ds_read_b64_tr_b16 a[76:77], v12 offset:12288
    ds_read_b64_tr_b16 a[78:79], v12 offset:12800
    v_mfma_f32_16x16x32_bf16 v[96:99], a[0:3], a[32:35], v[96:99]
    ds_read_b64_tr_b16 a[80:81], v13 offset:12288
    ds_read_b64_tr_b16 a[82:83], v13 offset:12800
    v_mfma_f32_16x16x32_bf16 v[104:107], a[4:7], a[32:35], v[104:107]
    ds_read_b128 a[72:75], v29
    ds_read_b64_tr_b16 a[100:101], v34 offset:12288
    v_mfma_f32_16x16x32_bf16 v[108:111], a[12:15], a[0:3], v[108:111]
    ds_read_b64_tr_b16 a[102:103], v34 offset:12800
    v_mfma_f32_16x16x32_bf16 v[116:119], a[12:15], a[4:7], v[116:119]
    s_add_u32 m0, s32, 86016
    s_nop 0
    buffer_load_dwordx4 v4, s[12:15], s79 offen offset:1024 lds
    buffer_load_dwordx4 v4, s[12:15], s79 offen offset:2048 lds
    v_mfma_f32_16x16x32_bf16 v[112:115], a[16:19], a[0:3], v[112:115]
    v_mfma_f32_16x16x32_bf16 v[120:123], a[16:19], a[4:7], v[120:123]
    s_add_u32 m0, s33, 86016
    s_mov_b64 exec, 0xffff
    buffer_load_dwordx4 v5, s[8:11], s71 offen lds
    s_mov_b64 exec, -1
    s_nop 0
    v_mfma_f32_16x16x32_bf16 v[124:127], a[8:11], a[36:39], v[124:127]
    s_waitcnt vmcnt(6) lgkmcnt(0)
    s_barrier
    v_mfma_f32_16x16x32_bf16 v[76:79], a[84:87], a[64:67], v[76:79]
    ds_read_b128 a[0:3], v8 offset:0
    ds_read_b64_tr_b16 a[20:21], v14 offset:1024
    v_mfma_f32_16x16x32_bf16 v[84:87], a[84:87], a[68:71], v[84:87]
    ds_read_b64_tr_b16 a[22:23], v14 offset:1536
    ds_read_b128 a[4:7], v8 offset:2048
    v_mfma_f32_16x16x32_bf16 v[80:83], a[88:91], a[64:67], v[80:83]
    ds_read_b64_tr_b16 a[24:25], v15 offset:1024
    ds_read_b64_tr_b16 a[26:27], v15 offset:1536
    v_mfma_f32_16x16x32_bf16 v[88:91], a[88:91], a[68:71], v[88:91]
    ds_read_b64_tr_b16 a[28:29], v14 offset:2048
    ds_read_b64_tr_b16 a[30:31], v14 offset:2560
    v_mfma_f32_16x16x32_bf16 v[92:95], a[64:67], a[92:95], v[92:95]
    ds_read_b64_tr_b16 a[32:33], v15 offset:2048
    ds_read_b64_tr_b16 a[34:35], v15 offset:2560
    v_mfma_f32_16x16x32_bf16 v[100:103], a[68:71], a[92:95], v[100:103]
    ds_read_b64_tr_b16 a[12:13], v14 offset:0
    ds_read_b64_tr_b16 a[14:15], v14 offset:512
    v_mfma_f32_16x16x32_bf16 v[96:99], a[64:67], a[96:99], v[96:99]
    ds_read_b64_tr_b16 a[16:17], v15 offset:0
    ds_read_b64_tr_b16 a[18:19], v15 offset:512
    v_mfma_f32_16x16x32_bf16 v[104:107], a[68:71], a[96:99], v[104:107]
    ds_read_b128 a[8:11], v30
    ds_read_b64_tr_b16 a[36:37], v35 offset:0
    v_mfma_f32_16x16x32_bf16 v[108:111], a[76:79], a[64:67], v[108:111]
    ds_read_b64_tr_b16 a[38:39], v35 offset:512
    v_mfma_f32_16x16x32_bf16 v[116:119], a[76:79], a[68:71], v[116:119]
    s_add_u32 m0, s32, 86016
    s_nop 0
    buffer_load_dwordx4 v4, s[12:15], s79 offen lds
    v_mfma_f32_16x16x32_bf16 v[112:115], a[80:83], a[64:67], v[112:115]
    v_mfma_f32_16x16x32_bf16 v[120:123], a[80:83], a[68:71], v[120:123]
    s_add_u32 m0, s31, 0
    s_nop 0
    buffer_load_dwordx4 v2, s[8:11], s72 offen lds
    buffer_load_dwordx4 v3, s[8:11], s72 offen offset:1024 lds
    v_mfma_f32_16x16x32_bf16 v[124:127], a[72:75], a[100:103], v[124:127]
    s_waitcnt lgkmcnt(0)
    v_mfma_f32_16x16x32_bf16 v[76:79], a[20:23], a[0:3], v[76:79]
    ds_read_b128 a[64:67], v9 offset:0
    ds_read_b64_tr_b16 a[84:85], v14 offset:13312
    v_mfma_f32_16x16x32_bf16 v[84:87], a[20:23], a[4:7], v[84:87]
    ds_read_b64_tr_b16 a[86:87], v14 offset:13824
    ds_read_b128 a[68:71], v9 offset:2048
    v_mfma_f32_16x16x32_bf16 v[80:83], a[24:27], a[0:3], v[80:83]
    ds_read_b64_tr_b16 a[88:89], v15 offset:13312
    ds_read_b64_tr_b16 a[90:91], v15 offset:13824
    v_mfma_f32_16x16x32_bf16 v[88:91], a[24:27], a[4:7], v[88:91]
    ds_read_b64_tr_b16 a[92:93], v14 offset:14336
    ds_read_b64_tr_b16 a[94:95], v14 offset:14848
    v_mfma_f32_16x16x32_bf16 v[92:95], a[0:3], a[28:31], v[92:95]
    ds_read_b64_tr_b16 a[96:97], v15 offset:14336
    ds_read_b64_tr_b16 a[98:99], v15 offset:14848
    v_mfma_f32_16x16x32_bf16 v[100:103], a[4:7], a[28:31], v[100:103]
    ds_read_b64_tr_b16 a[76:77], v14 offset:12288
    ds_read_b64_tr_b16 a[78:79], v14 offset:12800
    v_mfma_f32_16x16x32_bf16 v[96:99], a[0:3], a[32:35], v[96:99]
    ds_read_b64_tr_b16 a[80:81], v15 offset:12288
    ds_read_b64_tr_b16 a[82:83], v15 offset:12800
    v_mfma_f32_16x16x32_bf16 v[104:107], a[4:7], a[32:35], v[104:107]
    ds_read_b128 a[72:75], v31
    ds_read_b64_tr_b16 a[100:101], v35 offset:12288
    v_mfma_f32_16x16x32_bf16 v[108:111], a[12:15], a[0:3], v[108:111]
    ds_read_b64_tr_b16 a[102:103], v35 offset:12800
    v_mfma_f32_16x16x32_bf16 v[116:119], a[12:15], a[4:7], v[116:119]
    s_add_u32 m0, s32, 0
    s_nop 0
    buffer_load_dwordx4 v4, s[12:15], s80 offen offset:1024 lds
    buffer_load_dwordx4 v4, s[12:15], s80 offen offset:2048 lds
    v_mfma_f32_16x16x32_bf16 v[112:115], a[16:19], a[0:3], v[112:115]
    v_mfma_f32_16x16x32_bf16 v[120:123], a[16:19], a[4:7], v[120:123]
    s_add_u32 m0, s33, 0
    s_mov_b64 exec, 0xffff
    buffer_load_dwordx4 v5, s[8:11], s72 offen lds
    s_mov_b64 exec, -1
    s_nop 0
    v_mfma_f32_16x16x32_bf16 v[124:127], a[8:11], a[36:39], v[124:127]
    s_waitcnt vmcnt(5) lgkmcnt(0)
    s_barrier
    v_mfma_f32_16x16x32_bf16 v[76:79], a[84:87], a[64:67], v[76:79]
    ds_read_b128 a[0:3], v10 offset:0
    ds_read_b64_tr_b16 a[20:21], v16 offset:1024
    v_mfma_f32_16x16x32_bf16 v[84:87], a[84:87], a[68:71], v[84:87]
    ds_read_b64_tr_b16 a[22:23], v16 offset:1536
    ds_read_b128 a[4:7], v10 offset:2048
    v_mfma_f32_16x16x32_bf16 v[80:83], a[88:91], a[64:67], v[80:83]
    ds_read_b64_tr_b16 a[24:25], v17 offset:1024
    ds_read_b64_tr_b16 a[26:27], v17 offset:1536
    v_mfma_f32_16x16x32_bf16 v[88:91], a[88:91], a[68:71], v[88:91]
    ds_read_b64_tr_b16 a[28:29], v16 offset:2048
    ds_read_b64_tr_b16 a[30:31], v16 offset:2560
    v_mfma_f32_16x16x32_bf16 v[92:95], a[64:67], a[92:95], v[92:95]
    ds_read_b64_tr_b16 a[32:33], v17 offset:2048
    ds_read_b64_tr_b16 a[34:35], v17 offset:2560
    v_mfma_f32_16x16x32_bf16 v[100:103], a[68:71], a[92:95], v[100:103]
    ds_read_b64_tr_b16 a[12:13], v16 offset:0
    ds_read_b64_tr_b16 a[14:15], v16 offset:512
    v_mfma_f32_16x16x32_bf16 v[96:99], a[64:67], a[96:99], v[96:99]
    ds_read_b64_tr_b16 a[16:17], v17 offset:0
    ds_read_b64_tr_b16 a[18:19], v17 offset:512
    v_mfma_f32_16x16x32_bf16 v[104:107], a[68:71], a[96:99], v[104:107]
    ds_read_b128 a[8:11], v32
    ds_read_b64_tr_b16 a[36:37], v36 offset:0
    v_mfma_f32_16x16x32_bf16 v[108:111], a[76:79], a[64:67], v[108:111]
    ds_read_b64_tr_b16 a[38:39], v36 offset:512
    v_mfma_f32_16x16x32_bf16 v[116:119], a[76:79], a[68:71], v[116:119]
    s_add_u32 m0, s32, 0
    s_nop 0
    buffer_load_dwordx4 v4, s[12:15], s80 offen lds
    v_mfma_f32_16x16x32_bf16 v[112:115], a[80:83], a[64:67], v[112:115]
    v_mfma_f32_16x16x32_bf16 v[120:123], a[80:83], a[68:71], v[120:123]
    s_add_u32 m0, s31, 43008
    s_nop 0
    buffer_load_dwordx4 v2, s[8:11], s73 offen lds
    buffer_load_dwordx4 v3, s[8:11], s73 offen offset:1024 lds
    v_mfma_f32_16x16x32_bf16 v[124:127], a[72:75], a[100:103], v[124:127]
    s_waitcnt lgkmcnt(0)
    v_mfma_f32_16x16x32_bf16 v[76:79], a[20:23], a[0:3], v[76:79]
    ds_read_b128 a[64:67], v11 offset:0
    ds_read_b64_tr_b16 a[84:85], v16 offset:13312
    v_mfma_f32_16x16x32_bf16 v[84:87], a[20:23], a[4:7], v[84:87]
    ds_read_b64_tr_b16 a[86:87], v16 offset:13824
    ds_read_b128 a[68:71], v11 offset:2048
    v_mfma_f32_16x16x32_bf16 v[80:83], a[24:27], a[0:3], v[80:83]
    ds_read_b64_tr_b16 a[88:89], v17 offset:13312
    ds_read_b64_tr_b16 a[90:91], v17 offset:13824
    v_mfma_f32_16x16x32_bf16 v[88:91], a[24:27], a[4:7], v[88:91]
    ds_read_b64_tr_b16 a[92:93], v16 offset:14336
    ds_read_b64_tr_b16 a[94:95], v16 offset:14848
    v_mfma_f32_16x16x32_bf16 v[92:95], a[0:3], a[28:31], v[92:95]
    ds_read_b64_tr_b16 a[96:97], v17 offset:14336
    ds_read_b64_tr_b16 a[98:99], v17 offset:14848
    v_mfma_f32_16x16x32_bf16 v[100:103], a[4:7], a[28:31], v[100:103]
    ds_read_b64_tr_b16 a[76:77], v16 offset:12288
    ds_read_b64_tr_b16 a[78:79], v16 offset:12800
    v_mfma_f32_16x16x32_bf16 v[96:99], a[0:3], a[32:35], v[96:99]
    ds_read_b64_tr_b16 a[80:81], v17 offset:12288
    ds_read_b64_tr_b16 a[82:83], v17 offset:12800
    v_mfma_f32_16x16x32_bf16 v[104:107], a[4:7], a[32:35], v[104:107]
    ds_read_b128 a[72:75], v33
    ds_read_b64_tr_b16 a[100:101], v36 offset:12288
    v_mfma_f32_16x16x32_bf16 v[108:111], a[12:15], a[0:3], v[108:111]
    ds_read_b64_tr_b16 a[102:103], v36 offset:12800
    v_mfma_f32_16x16x32_bf16 v[116:119], a[12:15], a[4:7], v[116:119]
    s_add_u32 m0, s32, 43008
    s_nop 0
    buffer_load_dwordx4 v4, s[12:15], s81 offen offset:1024 lds
    buffer_load_dwordx4 v4, s[12:15], s81 offen offset:2048 lds
    v_mfma_f32_16x16x32_bf16 v[112:115], a[16:19], a[0:3], v[112:115]
    v_mfma_f32_16x16x32_bf16 v[120:123], a[16:19], a[4:7], v[120:123]
    s_add_u32 m0, s33, 43008
    s_mov_b64 exec, 0xffff
    buffer_load_dwordx4 v5, s[8:11], s73 offen lds
    s_mov_b64 exec, -1
    s_nop 0
    v_mfma_f32_16x16x32_bf16 v[124:127], a[8:11], a[36:39], v[124:127]
    s_waitcnt vmcnt(5) lgkmcnt(0)
    s_barrier
    v_mfma_f32_16x16x32_bf16 v[76:79], a[84:87], a[64:67], v[76:79]
    ds_read_b128 a[0:3], v6 offset:0
    ds_read_b64_tr_b16 a[20:21], v12 offset:1024
    v_mfma_f32_16x16x32_bf16 v[84:87], a[84:87], a[68:71], v[84:87]
    ds_read_b64_tr_b16 a[22:23], v12 offset:1536
    ds_read_b128 a[4:7], v6 offset:2048
    v_mfma_f32_16x16x32_bf16 v[80:83], a[88:91], a[64:67], v[80:83]
    ds_read_b64_tr_b16 a[24:25], v13 offset:1024
    ds_read_b64_tr_b16 a[26:27], v13 offset:1536
    v_mfma_f32_16x16x32_bf16 v[88:91], a[88:91], a[68:71], v[88:91]
    ds_read_b64_tr_b16 a[28:29], v12 offset:2048
    ds_read_b64_tr_b16 a[30:31], v12 offset:2560
    v_mfma_f32_16x16x32_bf16 v[92:95], a[64:67], a[92:95], v[92:95]
    ds_read_b64_tr_b16 a[32:33], v13 offset:2048
    ds_read_b64_tr_b16 a[34:35], v13 offset:2560
    v_mfma_f32_16x16x32_bf16 v[100:103], a[68:71], a[92:95], v[100:103]
    ds_read_b64_tr_b16 a[12:13], v12 offset:0
    ds_read_b64_tr_b16 a[14:15], v12 offset:512
    v_mfma_f32_16x16x32_bf16 v[96:99], a[64:67], a[96:99], v[96:99]
    ds_read_b64_tr_b16 a[16:17], v13 offset:0
    ds_read_b64_tr_b16 a[18:19], v13 offset:512
    v_mfma_f32_16x16x32_bf16 v[104:107], a[68:71], a[96:99], v[104:107]
    ds_read_b128 a[8:11], v28
    ds_read_b64_tr_b16 a[36:37], v34 offset:0
    v_mfma_f32_16x16x32_bf16 v[108:111], a[76:79], a[64:67], v[108:111]
    ds_read_b64_tr_b16 a[38:39], v34 offset:512
    v_mfma_f32_16x16x32_bf16 v[116:119], a[76:79], a[68:71], v[116:119]
    s_add_u32 m0, s32, 43008
    s_nop 0
    buffer_load_dwordx4 v4, s[12:15], s81 offen lds
    v_mfma_f32_16x16x32_bf16 v[112:115], a[80:83], a[64:67], v[112:115]
    v_mfma_f32_16x16x32_bf16 v[120:123], a[80:83], a[68:71], v[120:123]
    v_mfma_f32_16x16x32_bf16 v[124:127], a[72:75], a[100:103], v[124:127]
    s_waitcnt lgkmcnt(0)
    v_mfma_f32_16x16x32_bf16 v[76:79], a[20:23], a[0:3], v[76:79]
    ds_read_b128 a[64:67], v7 offset:0
    ds_read_b64_tr_b16 a[84:85], v12 offset:13312
    v_mfma_f32_16x16x32_bf16 v[84:87], a[20:23], a[4:7], v[84:87]
    ds_read_b64_tr_b16 a[86:87], v12 offset:13824
    ds_read_b128 a[68:71], v7 offset:2048
    v_mfma_f32_16x16x32_bf16 v[80:83], a[24:27], a[0:3], v[80:83]
    ds_read_b64_tr_b16 a[88:89], v13 offset:13312
    ds_read_b64_tr_b16 a[90:91], v13 offset:13824
    v_mfma_f32_16x16x32_bf16 v[88:91], a[24:27], a[4:7], v[88:91]
    ds_read_b64_tr_b16 a[92:93], v12 offset:14336
    ds_read_b64_tr_b16 a[94:95], v12 offset:14848
    v_mfma_f32_16x16x32_bf16 v[92:95], a[0:3], a[28:31], v[92:95]
    ds_read_b64_tr_b16 a[96:97], v13 offset:14336
    ds_read_b64_tr_b16 a[98:99], v13 offset:14848
    v_mfma_f32_16x16x32_bf16 v[100:103], a[4:7], a[28:31], v[100:103]
    ds_read_b64_tr_b16 a[76:77], v12 offset:12288
    ds_read_b64_tr_b16 a[78:79], v12 offset:12800
    v_mfma_f32_16x16x32_bf16 v[96:99], a[0:3], a[32:35], v[96:99]
    ds_read_b64_tr_b16 a[80:81], v13 offset:12288
    ds_read_b64_tr_b16 a[82:83], v13 offset:12800
    v_mfma_f32_16x16x32_bf16 v[104:107], a[4:7], a[32:35], v[104:107]
    ds_read_b128 a[72:75], v29
    ds_read_b64_tr_b16 a[100:101], v34 offset:12288
    v_mfma_f32_16x16x32_bf16 v[108:111], a[12:15], a[0:3], v[108:111]
    ds_read_b64_tr_b16 a[102:103], v34 offset:12800
    v_mfma_f32_16x16x32_bf16 v[116:119], a[12:15], a[4:7], v[116:119]
    v_mfma_f32_16x16x32_bf16 v[112:115], a[16:19], a[0:3], v[112:115]
    v_mfma_f32_16x16x32_bf16 v[120:123], a[16:19], a[4:7], v[120:123]
    v_mfma_f32_16x16x32_bf16 v[124:127], a[8:11], a[36:39], v[124:127]
    s_waitcnt vmcnt(0) lgkmcnt(0)
    s_barrier
    v_mfma_f32_16x16x32_bf16 v[76:79], a[84:87], a[64:67], v[76:79]
    ds_read_b128 a[0:3], v8 offset:0
    ds_read_b64_tr_b16 a[20:21], v14 offset:1024
    v_mfma_f32_16x16x32_bf16 v[84:87], a[84:87], a[68:71], v[84:87]
    ds_read_b64_tr_b16 a[22:23], v14 offset:1536
    ds_read_b128 a[4:7], v8 offset:2048
    v_mfma_f32_16x16x32_bf16 v[80:83], a[88:91], a[64:67], v[80:83]
    ds_read_b64_tr_b16 a[24:25], v15 offset:1024
    ds_read_b64_tr_b16 a[26:27], v15 offset:1536
    v_mfma_f32_16x16x32_bf16 v[88:91], a[88:91], a[68:71], v[88:91]
    ds_read_b64_tr_b16 a[28:29], v14 offset:2048
    ds_read_b64_tr_b16 a[30:31], v14 offset:2560
    v_mfma_f32_16x16x32_bf16 v[92:95], a[64:67], a[92:95], v[92:95]
    ds_read_b64_tr_b16 a[32:33], v15 offset:2048
    ds_read_b64_tr_b16 a[34:35], v15 offset:2560
    v_mfma_f32_16x16x32_bf16 v[100:103], a[68:71], a[92:95], v[100:103]
    ds_read_b64_tr_b16 a[12:13], v14 offset:0
    ds_read_b64_tr_b16 a[14:15], v14 offset:512
    v_mfma_f32_16x16x32_bf16 v[96:99], a[64:67], a[96:99], v[96:99]
    ds_read_b64_tr_b16 a[16:17], v15 offset:0
    ds_read_b64_tr_b16 a[18:19], v15 offset:512
    v_mfma_f32_16x16x32_bf16 v[104:107], a[68:71], a[96:99], v[104:107]
    ds_read_b128 a[8:11], v30
    ds_read_b64_tr_b16 a[36:37], v35 offset:0
    v_mfma_f32_16x16x32_bf16 v[108:111], a[76:79], a[64:67], v[108:111]
    ds_read_b64_tr_b16 a[38:39], v35 offset:512
    v_mfma_f32_16x16x32_bf16 v[116:119], a[76:79], a[68:71], v[116:119]
    v_mfma_f32_16x16x32_bf16 v[112:115], a[80:83], a[64:67], v[112:115]
    v_mfma_f32_16x16x32_bf16 v[120:123], a[80:83], a[68:71], v[120:123]
    v_mfma_f32_16x16x32_bf16 v[124:127], a[72:75], a[100:103], v[124:127]
    s_waitcnt lgkmcnt(0)
    v_mfma_f32_16x16x32_bf16 v[76:79], a[20:23], a[0:3], v[76:79]
    ds_read_b128 a[64:67], v9 offset:0
    ds_read_b64_tr_b16 a[84:85], v14 offset:13312
    v_mfma_f32_16x16x32_bf16 v[84:87], a[20:23], a[4:7], v[84:87]
    ds_read_b64_tr_b16 a[86:87], v14 offset:13824
    ds_read_b128 a[68:71], v9 offset:2048
    v_mfma_f32_16x16x32_bf16 v[80:83], a[24:27], a[0:3], v[80:83]
    ds_read_b64_tr_b16 a[88:89], v15 offset:13312
    ds_read_b64_tr_b16 a[90:91], v15 offset:13824
    v_mfma_f32_16x16x32_bf16 v[88:91], a[24:27], a[4:7], v[88:91]
    ds_read_b64_tr_b16 a[92:93], v14 offset:14336
    ds_read_b64_tr_b16 a[94:95], v14 offset:14848
    v_mfma_f32_16x16x32_bf16 v[92:95], a[0:3], a[28:31], v[92:95]
    ds_read_b64_tr_b16 a[96:97], v15 offset:14336
    ds_read_b64_tr_b16 a[98:99], v15 offset:14848
    v_mfma_f32_16x16x32_bf16 v[100:103], a[4:7], a[28:31], v[100:103]
    ds_read_b64_tr_b16 a[76:77], v14 offset:12288
    ds_read_b64_tr_b16 a[78:79], v14 offset:12800
    v_mfma_f32_16x16x32_bf16 v[96:99], a[0:3], a[32:35], v[96:99]
    ds_read_b64_tr_b16 a[80:81], v15 offset:12288
    ds_read_b64_tr_b16 a[82:83], v15 offset:12800
    v_mfma_f32_16x16x32_bf16 v[104:107], a[4:7], a[32:35], v[104:107]
    ds_read_b128 a[72:75], v31
    ds_read_b64_tr_b16 a[100:101], v35 offset:12288
    v_mfma_f32_16x16x32_bf16 v[108:111], a[12:15], a[0:3], v[108:111]
    ds_read_b64_tr_b16 a[102:103], v35 offset:12800
    v_mfma_f32_16x16x32_bf16 v[116:119], a[12:15], a[4:7], v[116:119]
    s_cmp_lg_u32 s24, 7
    s_cbranch_scc1 WT_1004
    s_lshr_b32 s34, s2, 3
    s_and_b32 s34, s34, 7
    s_lshl_b32 s34, s34, 16
    s_lshl_b32 s35, s55, 7
    s_add_u32 s34, s34, s35
    v_lshlrev_b32 v23, 10, v1
    buffer_load_dword v21, v23, s[4:7], s34 offen
    buffer_load_dword v21, v23, s[20:23], s34 offen
WT_1004:
    v_mfma_f32_16x16x32_bf16 v[112:115], a[16:19], a[0:3], v[112:115]
    v_mfma_f32_16x16x32_bf16 v[120:123], a[16:19], a[4:7], v[120:123]
    v_mfma_f32_16x16x32_bf16 v[124:127], a[8:11], a[36:39], v[124:127]
    s_waitcnt lgkmcnt(0)
    v_mfma_f32_16x16x32_bf16 v[76:79], a[84:87], a[64:67], v[76:79]
    v_mfma_f32_16x16x32_bf16 v[84:87], a[84:87], a[68:71], v[84:87]
    v_mfma_f32_16x16x32_bf16 v[80:83], a[88:91], a[64:67], v[80:83]
    v_mfma_f32_16x16x32_bf16 v[88:91], a[88:91], a[68:71], v[88:91]
    v_mfma_f32_16x16x32_bf16 v[92:95], a[64:67], a[92:95], v[92:95]
    v_mfma_f32_16x16x32_bf16 v[100:103], a[68:71], a[92:95], v[100:103]
    v_mfma_f32_16x16x32_bf16 v[96:99], a[64:67], a[96:99], v[96:99]
    v_mfma_f32_16x16x32_bf16 v[104:107], a[68:71], a[96:99], v[104:107]
    v_mfma_f32_16x16x32_bf16 v[108:111], a[76:79], a[64:67], v[108:111]
    v_mfma_f32_16x16x32_bf16 v[116:119], a[76:79], a[68:71], v[116:119]
    v_mfma_f32_16x16x32_bf16 v[112:115], a[80:83], a[64:67], v[112:115]
    v_mfma_f32_16x16x32_bf16 v[120:123], a[80:83], a[68:71], v[120:123]
    v_mfma_f32_16x16x32_bf16 v[124:127], a[72:75], a[100:103], v[124:127]
    v_cvt_pk_bf16_f32 v60, v76, v77
    v_cvt_pk_bf16_f32 v61, v78, v79
    v_cvt_pk_bf16_f32 v62, v84, v85
    v_cvt_pk_bf16_f32 v63, v86, v87
    v_cvt_pk_bf16_f32 v64, v80, v81
    v_cvt_pk_bf16_f32 v65, v82, v83
    v_cvt_pk_bf16_f32 v66, v88, v89
    v_cvt_pk_bf16_f32 v67, v90, v91
    v_cvt_pk_bf16_f32 v70, v92, v93
    v_cvt_pk_bf16_f32 v71, v94, v95
    v_cvt_pk_bf16_f32 v72, v100, v101
    v_cvt_pk_bf16_f32 v73, v102, v103
    v_cvt_pk_bf16_f32 v76, v96, v97
    v_cvt_pk_bf16_f32 v77, v98, v99
    v_cvt_pk_bf16_f32 v78, v104, v105
    v_cvt_pk_bf16_f32 v79, v106, v107
    v_cvt_pk_bf16_f32 v58, v124, v125
    v_cvt_pk_bf16_f32 v59, v126, v127
    s_cmp_eq_u32 s38, 3
    s_cbranch_scc1 B_NOW_5
    ds_write_b64 v56, v[62:63] offset:2048
    ds_write_b64 v56, v[72:73] offset:2560
    ds_write_b64 v56, v[66:67] offset:3072
    ds_write_b64 v56, v[78:79] offset:3584
B_NOW_5:
    s_cmp_ge_u32 s38, 2
    s_cbranch_scc1 B_HV_6
    ds_write_b16 v57, v58 offset:0
    ds_write_b16_d16_hi v57, v58 offset:8
    ds_write_b16 v57, v59 offset:16
    ds_write_b16_d16_hi v57, v59 offset:24
    s_branch B_HD_7
B_HV_6:
    ds_write_b64 v57, v[58:59]
B_HD_7:
    v_cvt_pk_bf16_f32 v100, v108, v109
    v_cvt_pk_bf16_f32 v101, v110, v111
    v_cvt_pk_bf16_f32 v102, v112, v113
    v_cvt_pk_bf16_f32 v103, v114, v115
    v_cvt_pk_bf16_f32 v104, v116, v117
    v_cvt_pk_bf16_f32 v105, v118, v119
    v_cvt_pk_bf16_f32 v106, v120, v121
    v_cvt_pk_bf16_f32 v107, v122, v123
    v_lshrrev_b32 v24, 3, v1
    v_lshrrev_b32 v25, 4, v1
    v_lshlrev_b32 v25, 1, v25
    v_and_b32 v26, 7, v1
    v_xor_b32 v25, v25, v26
    v_lshlrev_b32 v25, 4, v25
    v_lshl_add_u32 v5, v24, 10, v25
    v_add_u32 v5, s65, v5
    s_lshl_b32 s33, s24, 10
    s_waitcnt lgkmcnt(0)
    s_barrier
    ds_read_b64 v[80:81], v56 offset:0
    ds_read_b64 v[68:69], v56 offset:512
    ds_read_b64 v[82:83], v56 offset:1024
    ds_read_b64 v[74:75], v56 offset:1536
    v_mfma_f32_16x16x16_bf16 v[92:95], v[60:61], v[104:105], v[44:47]
    v_mfma_f32_16x16x16_bf16 v[116:119], v[62:63], v[104:105], v[40:43]
    v_mfma_f32_16x16x16_bf16 v[96:99], v[64:65], v[106:107], v[44:47]
    v_mfma_f32_16x16x16_bf16 v[120:123], v[66:67], v[106:107], v[40:43]
    s_waitcnt lgkmcnt(0)
    v_mfma_f32_16x16x16_bf16 v[84:87], v[80:81], v[100:101], v[48:51]
    v_mfma_f32_16x16x16_bf16 v[108:111], v[60:61], v[100:101], v[40:43]
    v_mfma_f32_16x16x16_bf16 v[88:91], v[82:83], v[102:103], v[48:51]
    v_mfma_f32_16x16x16_bf16 v[112:115], v[64:65], v[102:103], v[40:43]
    s_nop 4
    v_max3_f32 v28, v84, v85, v86
    s_nop 0
    v_max3_f32 v29, v88, v89, v90
    v_max3_f32 v30, v92, v93, v94
    v_max3_f32 v31, v96, v97, v98
    v_max3_f32 v28, v28, v87, v108
    v_max3_f32 v29, v29, v91, v112
    v_max3_f32 v30, v30, v95, v116
    v_max3_f32 v31, v31, v99, v120
    v_max3_f32 v28, v28, v109, v110
    v_max3_f32 v29, v29, v113, v114
    v_max3_f32 v30, v30, v117, v118
    v_max3_f32 v31, v31, v121, v122
    v_max_f32 v28, v28, v111
    v_max_f32 v29, v29, v115
    s_lshl_b32 s34, s66, 9
    s_add_u32 m0, s33, 73728
    s_nop 0
    buffer_load_dwordx4 v5, s[20:23], s34 offen lds
    v_max_f32 v30, v30, v119
    v_max_f32 v31, v31, v123
    v_mov_b32 v32, v28
    v_mov_b32 v33, v29
    v_mov_b32 v34, v30
    v_mov_b32 v35, v31
    v_permlane32_swap_b32 v28, v32
    v_permlane32_swap_b32 v29, v33
    v_permlane32_swap_b32 v30, v34
    v_permlane32_swap_b32 v31, v35
    v_max_f32 v28, v28, v32
    v_max_f32 v29, v29, v33
    v_max_f32 v30, v30, v34
    v_max_f32 v31, v31, v35
    s_lshl_b32 s34, s67, 9
    s_add_u32 m0, s33, 81920
    s_nop 0
    buffer_load_dwordx4 v5, s[20:23], s34 offen lds
    v_mov_b32 v32, v28
    v_mov_b32 v33, v29
    v_mov_b32 v34, v30
    v_mov_b32 v35, v31
    v_permlane16_swap_b32 v28, v32
    v_permlane16_swap_b32 v29, v33
    v_permlane16_swap_b32 v30, v34
    v_permlane16_swap_b32 v31, v35
    v_max_f32 v28, v28, v32
    v_max_f32 v29, v29, v33
    v_max_f32 v30, v30, v34
    v_max_f32 v31, v31, v35
    v_mul_f32 v28, v28, v20
    v_mul_f32 v29, v29, v20
    s_lshl_b32 s34, s68, 9
    s_add_u32 m0, s33, 90112
    s_nop 0
    buffer_load_dwordx4 v5, s[20:23], s34 offen lds
    v_mul_f32 v30, v30, v20
    v_mul_f32 v31, v31, v20
    v_fma_f32 v84, v84, v20, -v28
    v_fma_f32 v85, v85, v20, -v28
    v_fma_f32 v86, v86, v20, -v28
    v_fma_f32 v87, v87, v20, -v28
    v_fma_f32 v108, v108, v20, -v28
    v_fma_f32 v109, v109, v20, -v28
    v_fma_f32 v110, v110, v20, -v28
    v_fma_f32 v111, v111, v20, -v28
    v_fma_f32 v88, v88, v20, -v29
    v_fma_f32 v89, v89, v20, -v29
    v_fma_f32 v90, v90, v20, -v29
    v_fma_f32 v91, v91, v20, -v29
    s_lshl_b32 s34, s69, 9
    s_add_u32 m0, s33, 98304
    s_nop 0
    buffer_load_dwordx4 v5, s[20:23], s34 offen lds
    v_fma_f32 v112, v112, v20, -v29
    v_fma_f32 v113, v113, v20, -v29
    v_fma_f32 v114, v114, v20, -v29
    v_fma_f32 v115, v115, v20, -v29
    v_fma_f32 v92, v92, v20, -v30
    v_fma_f32 v93, v93, v20, -v30
    v_fma_f32 v94, v94, v20, -v30
    v_fma_f32 v95, v95, v20, -v30
    v_fma_f32 v116, v116, v20, -v30
    v_fma_f32 v117, v117, v20, -v30
    v_fma_f32 v118, v118, v20, -v30
    v_fma_f32 v119, v119, v20, -v30
    v_fma_f32 v96, v96, v20, -v31
    s_lshl_b32 s34, s70, 9
    s_add_u32 m0, s33, 106496
    s_nop 0
    buffer_load_dwordx4 v5, s[20:23], s34 offen lds
    v_fma_f32 v97, v97, v20, -v31
    v_fma_f32 v98, v98, v20, -v31
    v_fma_f32 v99, v99, v20, -v31
    v_fma_f32 v120, v120, v20, -v31
    v_fma_f32 v121, v121, v20, -v31
    v_fma_f32 v122, v122, v20, -v31
    v_fma_f32 v123, v123, v20, -v31
    v_exp_f32 v84, v84
    v_exp_f32 v85, v85
    v_exp_f32 v86, v86
    v_exp_f32 v87, v87
    v_exp_f32 v108, v108
    v_exp_f32 v109, v109
    v_exp_f32 v110, v110
    s_lshl_b32 s34, s71, 9
    s_add_u32 m0, s33, 114688
    s_nop 0
    buffer_load_dwordx4 v5, s[20:23], s34 offen lds
    v_exp_f32 v111, v111
    v_exp_f32 v88, v88
    v_exp_f32 v89, v89
    v_exp_f32 v90, v90
    v_exp_f32 v91, v91
    v_exp_f32 v112, v112
    v_exp_f32 v113, v113
    v_exp_f32 v114, v114
    v_exp_f32 v115, v115
    v_exp_f32 v92, v92
    v_exp_f32 v93, v93
    v_exp_f32 v94, v94
    v_exp_f32 v95, v95
    v_exp_f32 v116, v116
    s_lshl_b32 s34, s72, 9
    s_add_u32 m0, s33, 122880
    s_nop 0
    buffer_load_dwordx4 v5, s[20:23], s34 offen lds
    v_exp_f32 v117, v117
    v_exp_f32 v118, v118
    v_exp_f32 v119, v119
    v_exp_f32 v96, v96
    v_exp_f32 v97, v97
    v_exp_f32 v98, v98
    v_exp_f32 v99, v99
    v_exp_f32 v120, v120
    v_exp_f32 v121, v121
    v_exp_f32 v122, v122
    v_exp_f32 v123, v123
    v_cvt_pk_bf16_f32 v36, v84, v85
    v_cvt_pk_bf16_f32 v37, v86, v87
    v_cvt_pk_bf16_f32 v38, v108, v109
    s_lshl_b32 s34, s73, 9
    s_add_u32 m0, s33, 131072
    s_nop 0
    buffer_load_dwordx4 v5, s[20:23], s34 offen lds
    v_cvt_pk_bf16_f32 v39, v110, v111
    v_cvt_pk_bf16_f32 v40, v88, v89
    v_cvt_pk_bf16_f32 v41, v90, v91
    v_cvt_pk_bf16_f32 v42, v112, v113
    v_cvt_pk_bf16_f32 v43, v114, v115
    v_cvt_pk_bf16_f32 v44, v92, v93
    v_cvt_pk_bf16_f32 v45, v94, v95
    v_cvt_pk_bf16_f32 v46, v116, v117
    v_cvt_pk_bf16_f32 v47, v118, v119
    v_cvt_pk_bf16_f32 v48, v96, v97
    v_cvt_pk_bf16_f32 v49, v98, v99
    v_cvt_pk_bf16_f32 v50, v120, v121
    v_cvt_pk_bf16_f32 v51, v122, v123
    v_mfma_f32_16x16x32_bf16 v[108:111], v[52:55], v[36:39], 0
    v_mfma_f32_16x16x32_bf16 v[112:115], v[52:55], v[40:43], 0
    v_mfma_f32_16x16x32_bf16 v[116:119], v[52:55], v[44:47], 0
    v_mfma_f32_16x16x32_bf16 v[120:123], v[52:55], v[48:51], 0
    v_mfma_f32_16x16x32_bf16 v[84:87], v[68:71], v[36:39], 0
    v_mfma_f32_16x16x32_bf16 v[88:91], v[74:77], v[40:43], 0
    v_mfma_f32_16x16x32_bf16 v[92:95], v[70:73], v[44:47], 0
    v_mfma_f32_16x16x32_bf16 v[96:99], v[76:79], v[48:51], 0
    s_lshl_b32 s34, s25, 3
    s_lshl_b32 s35, s38, 1
    s_add_u32 s34, s34, s35
    s_lshl_b32 s34, s34, 5
    s_lshl_b32 s35, s26, 1
    s_add_u32 s34, s34, s35
    s_add_u32 s34, s34, s39
    s_add_u32 s34, s34, 16
    s_lshl_b32 s34, s34, 10
    s_add_u32 s50, s34, 1048576
    s_add_u32 s51, s50, 32768
    v_lshlrev_b32 v24, 4, v1
    v_rcp_f32 v108, v108
    v_rcp_f32 v112, v112
    v_rcp_f32 v116, v116
    v_rcp_f32 v120, v120
    v_mul_f32 v84, v84, v108
    v_mul_f32 v85, v85, v108
    v_mul_f32 v86, v86, v108
    v_mul_f32 v87, v87, v108
    v_cvt_pk_bf16_f32 v60, v84, v85
    v_cvt_pk_bf16_f32 v61, v86, v87
    v_mul_f32 v88, v88, v112
    v_mul_f32 v89, v89, v112
    v_mul_f32 v90, v90, v112
    v_mul_f32 v91, v91, v112
    v_cvt_pk_bf16_f32 v62, v88, v89
    v_cvt_pk_bf16_f32 v63, v90, v91
    buffer_store_dwordx4 v[60:63], v24, s[16:19], s50 offen sc1
    v_mul_f32 v92, v92, v116
    v_mul_f32 v93, v93, v116
    v_mul_f32 v94, v94, v116
    v_mul_f32 v95, v95, v116
    v_cvt_pk_bf16_f32 v64, v92, v93
    v_cvt_pk_bf16_f32 v65, v94, v95
    v_mul_f32 v96, v96, v120
    v_mul_f32 v97, v97, v120
    v_mul_f32 v98, v98, v120
    v_mul_f32 v99, v99, v120
    v_cvt_pk_bf16_f32 v66, v96, v97
    v_cvt_pk_bf16_f32 v67, v98, v99
    buffer_store_dwordx4 v[64:67], v24, s[16:19], s51 offen sc1
    s_waitcnt vmcnt(28)
    s_mov_b32 s43, 0
NW_8:
    v_readfirstlane_b32 s40, v22
    s_nop 3
    s_cmp_lg_u32 s40, 0
    s_cbranch_scc1 NOK_9
    s_add_u32 s43, s43, 1
    s_cmp_ge_u32 s43, 131072
    s_cbranch_scc1 NOK_9
    v_mov_b32 v27, 0
    global_load_dword v22, v27, s[58:59] sc1
    s_waitcnt vmcnt(0)
    s_branch NW_8
NOK_9:
L_P2:
    v_lshrrev_b32 v24, 4, v1
    v_bfe_u32 v25, v1, 2, 2
    v_lshrrev_b32 v26, 1, v25
    v_lshl_add_u32 v26, v24, 1, v26
    v_and_b32 v26, 3, v26
    v_lshlrev_b32 v26, 5, v26
    v_lshl_add_u32 v27, v24, 2, v25
    v_lshl_add_u32 v26, v27, 7, v26
    v_and_b32 v27, 3, v1
    v_lshl_add_u32 v26, v27, 3, v26
    s_mul_i32 s34, s39, 73728
    v_add_u32 v6, s34, v26
    v_xor_b32 v7, 32, v6
    v_xor_b32 v8, 64, v6
    v_xor_b32 v9, 96, v6
    v_lshlrev_b32 v10, 4, v1
    v_and_b32 v12, 7, v1
    v_lshlrev_b32 v12, 2, v12
    s_lshl_b32 s34, s25, 8
    s_lshl_b32 s35, s41, 7
    s_add_u32 s34, s34, s35
    s_lshl_b32 s35, s26, 2
    s_add_u32 s52, s34, s35
    s_lshr_b32 s34, s54, 1
    s_lshl_b32 s34, s34, 8
    s_lshl_b32 s35, s39, 7
    s_add_u32 s53, s34, s35
    s_lshl_b32 s50, s54, 2
    s_add_u32 s50, s50, s38
    s_lshl_b32 s51, s50, 6
    s_lshl_b32 s50, s50, 5
    s_lshl_b32 s34, s39, 4
    s_add_u32 s50, s50, s34
    s_lshl_b32 s50, s50, 10
    s_add_u32 s50, s50, 1048576
    s_waitcnt vmcnt(0)
    s_barrier
    s_cmp_lg_u32 s24, 0
    s_cbranch_scc1 NOFLAG_10
    v_mov_b32 v24, s40
    v_mov_b32 v25, 0
    s_mov_b64 exec, 1
    buffer_store_dword v24, v25, s[16:19], s52 offen offset:0 sc1
    s_mov_b64 exec, -1
NOFLAG_10:
    s_lshl_b32 s34, s24, 13
    s_lshl_b32 s35, s38, 13
    s_sub_u32 s34, s35, s34
    v_add_u32 v5, s34, v5
    v_add_u32 v4, 32768, v5
    s_lshl_b32 s33, s38, 10
    s_cmp_eq_u32 s41, 0
    s_cbranch_scc1 NOWO_11
    s_cmp_eq_u32 s39, 0
    s_cbranch_scc1 WOA_12
    s_branch NOWO_11
    s_lshl_b32 s34, s66, 9
    s_add_u32 m0, s33, 73728
    s_nop 0
    buffer_load_dwordx4 v5, s[20:23], s34 offen lds
    s_add_u32 m0, s33, 77824
    s_nop 0
    buffer_load_dwordx4 v4, s[20:23], s34 offen lds
    s_lshl_b32 s34, s67, 9
    s_add_u32 m0, s33, 81920
    s_nop 0
    buffer_load_dwordx4 v5, s[20:23], s34 offen lds
    s_add_u32 m0, s33, 86016
    s_nop 0
    buffer_load_dwordx4 v4, s[20:23], s34 offen lds
    s_lshl_b32 s34, s68, 9
    s_add_u32 m0, s33, 90112
    s_nop 0
    buffer_load_dwordx4 v5, s[20:23], s34 offen lds
    s_add_u32 m0, s33, 94208
    s_nop 0
    buffer_load_dwordx4 v4, s[20:23], s34 offen lds
    s_lshl_b32 s34, s69, 9
    s_add_u32 m0, s33, 98304
    s_nop 0
    buffer_load_dwordx4 v5, s[20:23], s34 offen lds
    s_add_u32 m0, s33, 102400
    s_nop 0
    buffer_load_dwordx4 v4, s[20:23], s34 offen lds
    s_lshl_b32 s34, s70, 9
    s_add_u32 m0, s33, 106496
    s_nop 0
    buffer_load_dwordx4 v5, s[20:23], s34 offen lds
    s_add_u32 m0, s33, 110592
    s_nop 0
    buffer_load_dwordx4 v4, s[20:23], s34 offen lds
    s_lshl_b32 s34, s71, 9
    s_add_u32 m0, s33, 114688
    s_nop 0
    buffer_load_dwordx4 v5, s[20:23], s34 offen lds
    s_add_u32 m0, s33, 118784
    s_nop 0
    buffer_load_dwordx4 v4, s[20:23], s34 offen lds
    s_lshl_b32 s34, s72, 9
    s_add_u32 m0, s33, 122880
    s_nop 0
    buffer_load_dwordx4 v5, s[20:23], s34 offen lds
    s_add_u32 m0, s33, 126976
    s_nop 0
    buffer_load_dwordx4 v4, s[20:23], s34 offen lds
    s_lshl_b32 s34, s73, 9
    s_add_u32 m0, s33, 131072
    s_nop 0
    buffer_load_dwordx4 v5, s[20:23], s34 offen lds
    s_add_u32 m0, s33, 135168
    s_nop 0
    buffer_load_dwordx4 v4, s[20:23], s34 offen lds
    s_branch WOD_13
WOA_12:
    s_lshl_b32 s34, s66, 9
    s_add_u32 m0, s33, 0
    s_nop 0
    buffer_load_dwordx4 v5, s[4:7], s34 offen lds
    s_add_u32 m0, s33, 4096
    s_nop 0
    buffer_load_dwordx4 v4, s[4:7], s34 offen lds
    s_lshl_b32 s34, s67, 9
    s_add_u32 m0, s33, 8192
    s_nop 0
    buffer_load_dwordx4 v5, s[4:7], s34 offen lds
    s_add_u32 m0, s33, 12288
    s_nop 0
    buffer_load_dwordx4 v4, s[4:7], s34 offen lds
    s_lshl_b32 s34, s68, 9
    s_add_u32 m0, s33, 16384
    s_nop 0
    buffer_load_dwordx4 v5, s[4:7], s34 offen lds
    s_add_u32 m0, s33, 20480
    s_nop 0
    buffer_load_dwordx4 v4, s[4:7], s34 offen lds
    s_lshl_b32 s34, s69, 9
    s_add_u32 m0, s33, 24576
    s_nop 0
    buffer_load_dwordx4 v5, s[4:7], s34 offen lds
    s_add_u32 m0, s33, 28672
    s_nop 0
    buffer_load_dwordx4 v4, s[4:7], s34 offen lds
    s_lshl_b32 s34, s70, 9
    s_add_u32 m0, s33, 32768
    s_nop 0
    buffer_load_dwordx4 v5, s[4:7], s34 offen lds
    s_add_u32 m0, s33, 36864
    s_nop 0
    buffer_load_dwordx4 v4, s[4:7], s34 offen lds
    s_lshl_b32 s34, s71, 9
    s_add_u32 m0, s33, 40960
    s_nop 0
    buffer_load_dwordx4 v5, s[4:7], s34 offen lds
    s_add_u32 m0, s33, 45056
    s_nop 0
    buffer_load_dwordx4 v4, s[4:7], s34 offen lds
    s_lshl_b32 s34, s72, 9
    s_add_u32 m0, s33, 49152
    s_nop 0
    buffer_load_dwordx4 v5, s[4:7], s34 offen lds
    s_add_u32 m0, s33, 53248
    s_nop 0
    buffer_load_dwordx4 v4, s[4:7], s34 offen lds
    s_lshl_b32 s34, s73, 9
    s_add_u32 m0, s33, 57344
    s_nop 0
    buffer_load_dwordx4 v5, s[4:7], s34 offen lds
    s_add_u32 m0, s33, 61440
    s_nop 0
    buffer_load_dwordx4 v4, s[4:7], s34 offen lds
WOD_13:
    s_lshr_b32 s34, s26, 1
    s_and_b32 s35, s26, 1
    s_lshl_b32 s35, s35, 2
    s_add_u32 s34, s34, s35
    s_lshl_b32 s35, s41, 4
    s_add_u32 s34, s34, s35
    s_cmp_lg_u32 s34, s24
    s_cbranch_scc1 A_NOGATE_14
    v_lshrrev_b32 v26, 4, v1
    v_lshlrev_b32 v26, 4, v26
    v_add_u32 v26, 139264, v26
    s_cmp_eq_u32 s39, 1
    s_cbranch_scc1 A_GB1_15
    ds_read_b128 v[28:31], v26 offset:0
    ds_read_b128 v[32:35], v26 offset:64
    ds_read_b128 v[36:39], v26 offset:128
    ds_read_b128 v[40:43], v26 offset:192
    s_waitcnt lgkmcnt(0)
    v_mfma_f32_16x16x32_bf16 v[44:47], v[28:31], a[0:3], 0
    v_mfma_f32_16x16x32_bf16 v[44:47], v[32:35], a[8:11], v[44:47]
    v_mfma_f32_16x16x32_bf16 v[44:47], v[36:39], a[16:19], v[44:47]
    v_mfma_f32_16x16x32_bf16 v[44:47], v[40:43], a[24:27], v[44:47]
    ds_read_b128 v[28:31], v26 offset:256
    ds_read_b128 v[32:35], v26 offset:320
    ds_read_b128 v[36:39], v26 offset:384
    ds_read_b128 v[40:43], v26 offset:448
    s_waitcnt lgkmcnt(0)
    v_mfma_f32_16x16x32_bf16 v[44:47], v[28:31], a[32:35], v[44:47]
    v_mfma_f32_16x16x32_bf16 v[44:47], v[32:35], a[40:43], v[44:47]
    v_mfma_f32_16x16x32_bf16 v[44:47], v[36:39], a[48:51], v[44:47]
    v_mfma_f32_16x16x32_bf16 v[44:47], v[40:43], a[56:59], v[44:47]
    ds_read_b128 v[28:31], v26 offset:512
    ds_read_b128 v[32:35], v26 offset:576
    ds_read_b128 v[36:39], v26 offset:640
    ds_read_b128 v[40:43], v26 offset:704
    s_waitcnt lgkmcnt(0)
    v_mfma_f32_16x16x32_bf16 v[44:47], v[28:31], a[64:67], v[44:47]
    v_mfma_f32_16x16x32_bf16 v[44:47], v[32:35], a[72:75], v[44:47]
    v_mfma_f32_16x16x32_bf16 v[44:47], v[36:39], a[80:83], v[44:47]
    v_mfma_f32_16x16x32_bf16 v[44:47], v[40:43], a[88:91], v[44:47]
    ds_read_b128 v[28:31], v26 offset:768
    ds_read_b128 v[32:35], v26 offset:832
    ds_read_b128 v[36:39], v26 offset:896
    ds_read_b128 v[40:43], v26 offset:960
    s_waitcnt lgkmcnt(0)
    v_mfma_f32_16x16x32_bf16 v[44:47], v[28:31], a[96:99], v[44:47]
    v_mfma_f32_16x16x32_bf16 v[44:47], v[32:35], a[104:107], v[44:47]
    v_mfma_f32_16x16x32_bf16 v[44:47], v[36:39], a[112:115], v[44:47]
    v_mfma_f32_16x16x32_bf16 v[44:47], v[40:43], a[120:123], v[44:47]
    s_branch A_GEND_16
A_GB1_15:
    ds_read_b128 v[28:31], v26 offset:0
    ds_read_b128 v[32:35], v26 offset:64
    ds_read_b128 v[36:39], v26 offset:128
    ds_read_b128 v[40:43], v26 offset:192
    s_waitcnt lgkmcnt(0)
    v_mfma_f32_16x16x32_bf16 v[44:47], v[28:31], a[4:7], 0
    v_mfma_f32_16x16x32_bf16 v[44:47], v[32:35], a[12:15], v[44:47]
    v_mfma_f32_16x16x32_bf16 v[44:47], v[36:39], a[20:23], v[44:47]
    v_mfma_f32_16x16x32_bf16 v[44:47], v[40:43], a[28:31], v[44:47]
    ds_read_b128 v[28:31], v26 offset:256
    ds_read_b128 v[32:35], v26 offset:320
    ds_read_b128 v[36:39], v26 offset:384
    ds_read_b128 v[40:43], v26 offset:448
    s_waitcnt lgkmcnt(0)
    v_mfma_f32_16x16x32_bf16 v[44:47], v[28:31], a[36:39], v[44:47]
    v_mfma_f32_16x16x32_bf16 v[44:47], v[32:35], a[44:47], v[44:47]
    v_mfma_f32_16x16x32_bf16 v[44:47], v[36:39], a[52:55], v[44:47]
    v_mfma_f32_16x16x32_bf16 v[44:47], v[40:43], a[60:63], v[44:47]
    ds_read_b128 v[28:31], v26 offset:512
    ds_read_b128 v[32:35], v26 offset:576
    ds_read_b128 v[36:39], v26 offset:640
    ds_read_b128 v[40:43], v26 offset:704
    s_waitcnt lgkmcnt(0)
    v_mfma_f32_16x16x32_bf16 v[44:47], v[28:31], a[68:71], v[44:47]
    v_mfma_f32_16x16x32_bf16 v[44:47], v[32:35], a[76:79], v[44:47]
    v_mfma_f32_16x16x32_bf16 v[44:47], v[36:39], a[84:87], v[44:47]
    v_mfma_f32_16x16x32_bf16 v[44:47], v[40:43], a[92:95], v[44:47]
    ds_read_b128 v[28:31], v26 offset:768
    ds_read_b128 v[32:35], v26 offset:832
    ds_read_b128 v[36:39], v26 offset:896
    ds_read_b128 v[40:43], v26 offset:960
    s_waitcnt lgkmcnt(0)
    v_mfma_f32_16x16x32_bf16 v[44:47], v[28:31], a[100:103], v[44:47]
    v_mfma_f32_16x16x32_bf16 v[44:47], v[32:35], a[108:111], v[44:47]
    v_mfma_f32_16x16x32_bf16 v[44:47], v[36:39], a[116:119], v[44:47]
    v_mfma_f32_16x16x32_bf16 v[44:47], v[40:43], a[124:127], v[44:47]
A_GEND_16:
    s_nop 7
    v_mul_f32 v45, v44, v20
    v_sub_f32 v45, 0, v45
    v_exp_f32 v45, v45
    s_nop 0
    v_add_f32 v45, 1.0, v45
    v_rcp_f32 v45, v45
    s_lshl_b32 s34, s25, 7
    s_lshl_b32 s35, s26, 4
    s_add_u32 s34, s34, s35
    s_lshl_b32 s34, s34, 3
    s_add_u32 s34, s34, 4096
    v_lshlrev_b32 v47, 3, v1
    v_mov_b32 v48, v45
    v_mov_b32 v49, s40
    s_mov_b64 exec, 0xffff
    buffer_store_dwordx2 v[48:49], v47, s[16:19], s34 offen sc1
    s_mov_b64 exec, -1
A_NOGATE_14:
    s_waitcnt vmcnt(0)
    s_lshl_b32 s34, s39, 2
    s_add_u32 s34, s34, 163784
    v_mov_b32 v24, s34
    v_mov_b32 v25, 1
    s_mov_b64 exec, 1
    ds_add_u32 v24, v25
    s_mov_b64 exec, -1
    s_mov_b32 s43, 0
WOSP_17:
    ds_read_b32 v25, v24
    s_waitcnt lgkmcnt(0)
    v_readfirstlane_b32 s34, v25
    s_nop 3
    s_cmp_ge_u32 s34, 4
    s_cbranch_scc1 WOGO_18
    s_add_u32 s43, s43, 1
    s_cmp_ge_u32 s43, 2097152
    s_cbranch_scc0 WOSP_17
WOGO_18:
    s_branch WOD_13_2
NOWO_11:
    s_lshr_b32 s34, s26, 1
    s_and_b32 s35, s26, 1
    s_lshl_b32 s35, s35, 2
    s_add_u32 s34, s34, s35
    s_lshl_b32 s35, s41, 4
    s_add_u32 s34, s34, s35
    s_cmp_lg_u32 s34, s24
    s_cbranch_scc1 A_NOGATE_19
    v_lshrrev_b32 v26, 4, v1
    v_lshlrev_b32 v26, 4, v26
    v_add_u32 v26, 139264, v26
    s_cmp_eq_u32 s39, 1
    s_cbranch_scc1 A_GB1_20
    ds_read_b128 v[28:31], v26 offset:0
    ds_read_b128 v[32:35], v26 offset:64
    ds_read_b128 v[36:39], v26 offset:128
    ds_read_b128 v[40:43], v26 offset:192
    s_waitcnt lgkmcnt(0)
    v_mfma_f32_16x16x32_bf16 v[44:47], v[28:31], a[0:3], 0
    v_mfma_f32_16x16x32_bf16 v[44:47], v[32:35], a[8:11], v[44:47]
    v_mfma_f32_16x16x32_bf16 v[44:47], v[36:39], a[16:19], v[44:47]
    v_mfma_f32_16x16x32_bf16 v[44:47], v[40:43], a[24:27], v[44:47]
    ds_read_b128 v[28:31], v26 offset:256
    ds_read_b128 v[32:35], v26 offset:320
    ds_read_b128 v[36:39], v26 offset:384
    ds_read_b128 v[40:43], v26 offset:448
    s_waitcnt lgkmcnt(0)
    v_mfma_f32_16x16x32_bf16 v[44:47], v[28:31], a[32:35], v[44:47]
    v_mfma_f32_16x16x32_bf16 v[44:47], v[32:35], a[40:43], v[44:47]
    v_mfma_f32_16x16x32_bf16 v[44:47], v[36:39], a[48:51], v[44:47]
    v_mfma_f32_16x16x32_bf16 v[44:47], v[40:43], a[56:59], v[44:47]
    ds_read_b128 v[28:31], v26 offset:512
    ds_read_b128 v[32:35], v26 offset:576
    ds_read_b128 v[36:39], v26 offset:640
    ds_read_b128 v[40:43], v26 offset:704
    s_waitcnt lgkmcnt(0)
    v_mfma_f32_16x16x32_bf16 v[44:47], v[28:31], a[64:67], v[44:47]
    v_mfma_f32_16x16x32_bf16 v[44:47], v[32:35], a[72:75], v[44:47]
    v_mfma_f32_16x16x32_bf16 v[44:47], v[36:39], a[80:83], v[44:47]
    v_mfma_f32_16x16x32_bf16 v[44:47], v[40:43], a[88:91], v[44:47]
    ds_read_b128 v[28:31], v26 offset:768
    ds_read_b128 v[32:35], v26 offset:832
    ds_read_b128 v[36:39], v26 offset:896
    ds_read_b128 v[40:43], v26 offset:960
    s_waitcnt lgkmcnt(0)
    v_mfma_f32_16x16x32_bf16 v[44:47], v[28:31], a[96:99], v[44:47]
    v_mfma_f32_16x16x32_bf16 v[44:47], v[32:35], a[104:107], v[44:47]
    v_mfma_f32_16x16x32_bf16 v[44:47], v[36:39], a[112:115], v[44:47]
    v_mfma_f32_16x16x32_bf16 v[44:47], v[40:43], a[120:123], v[44:47]
    s_branch A_GEND_21
A_GB1_20:
    ds_read_b128 v[28:31], v26 offset:0
    ds_read_b128 v[32:35], v26 offset:64
    ds_read_b128 v[36:39], v26 offset:128
    ds_read_b128 v[40:43], v26 offset:192
    s_waitcnt lgkmcnt(0)
    v_mfma_f32_16x16x32_bf16 v[44:47], v[28:31], a[4:7], 0
    v_mfma_f32_16x16x32_bf16 v[44:47], v[32:35], a[12:15], v[44:47]
    v_mfma_f32_16x16x32_bf16 v[44:47], v[36:39], a[20:23], v[44:47]
    v_mfma_f32_16x16x32_bf16 v[44:47], v[40:43], a[28:31], v[44:47]
    ds_read_b128 v[28:31], v26 offset:256
    ds_read_b128 v[32:35], v26 offset:320
    ds_read_b128 v[36:39], v26 offset:384
    ds_read_b128 v[40:43], v26 offset:448
    s_waitcnt lgkmcnt(0)
    v_mfma_f32_16x16x32_bf16 v[44:47], v[28:31], a[36:39], v[44:47]
    v_mfma_f32_16x16x32_bf16 v[44:47], v[32:35], a[44:47], v[44:47]
    v_mfma_f32_16x16x32_bf16 v[44:47], v[36:39], a[52:55], v[44:47]
    v_mfma_f32_16x16x32_bf16 v[44:47], v[40:43], a[60:63], v[44:47]
    ds_read_b128 v[28:31], v26 offset:512
    ds_read_b128 v[32:35], v26 offset:576
    ds_read_b128 v[36:39], v26 offset:640
    ds_read_b128 v[40:43], v26 offset:704
    s_waitcnt lgkmcnt(0)
    v_mfma_f32_16x16x32_bf16 v[44:47], v[28:31], a[68:71], v[44:47]
    v_mfma_f32_16x16x32_bf16 v[44:47], v[32:35], a[76:79], v[44:47]
    v_mfma_f32_16x16x32_bf16 v[44:47], v[36:39], a[84:87], v[44:47]
    v_mfma_f32_16x16x32_bf16 v[44:47], v[40:43], a[92:95], v[44:47]
    ds_read_b128 v[28:31], v26 offset:768
    ds_read_b128 v[32:35], v26 offset:832
    ds_read_b128 v[36:39], v26 offset:896
    ds_read_b128 v[40:43], v26 offset:960
    s_waitcnt lgkmcnt(0)
    v_mfma_f32_16x16x32_bf16 v[44:47], v[28:31], a[100:103], v[44:47]
    v_mfma_f32_16x16x32_bf16 v[44:47], v[32:35], a[108:111], v[44:47]
    v_mfma_f32_16x16x32_bf16 v[44:47], v[36:39], a[116:119], v[44:47]
    v_mfma_f32_16x16x32_bf16 v[44:47], v[40:43], a[124:127], v[44:47]
A_GEND_21:
    s_nop 7
    v_mul_f32 v45, v44, v20
    v_sub_f32 v45, 0, v45
    v_exp_f32 v45, v45
    s_nop 0
    v_add_f32 v45, 1.0, v45
    v_rcp_f32 v45, v45
    s_lshl_b32 s34, s25, 7
    s_lshl_b32 s35, s26, 4
    s_add_u32 s34, s34, s35
    s_lshl_b32 s34, s34, 3
    s_add_u32 s34, s34, 4096
    v_lshlrev_b32 v47, 3, v1
    v_mov_b32 v48, v45
    v_mov_b32 v49, s40
    s_mov_b64 exec, 0xffff
    buffer_store_dwordx2 v[48:49], v47, s[16:19], s34 offen sc1
    s_mov_b64 exec, -1
A_NOGATE_19:
WOD_13_2:
    s_mov_b32 s43, 0
    s_mov_b32 s44, 0
    v_mov_b32 v26, s40
    s_lshl_b32 s34, s39, 2
    s_add_u32 s34, s34, 163776
    v_mov_b32 v24, s34
    v_and_b32 v13, 15, v1
    v_lshlrev_b32 v13, 3, v13
    s_lshl_b32 s46, s51, 1
    s_add_u32 s46, s46, 4096
    ds_read_b64_tr_b16 v[28:29], v6 offset:0
    ds_read_b64_tr_b16 v[30:31], v6 offset:2048
    ds_read_b64_tr_b16 v[32:33], v7 offset:0
    ds_read_b64_tr_b16 v[34:35], v7 offset:2048
    ds_read_b64_tr_b16 v[36:37], v8 offset:0
    ds_read_b64_tr_b16 v[38:39], v8 offset:2048
    ds_read_b64_tr_b16 v[40:41], v9 offset:0
    ds_read_b64_tr_b16 v[42:43], v9 offset:2048
    ds_read_b64_tr_b16 v[44:45], v6 offset:4096
    ds_read_b64_tr_b16 v[46:47], v6 offset:6144
    ds_read_b64_tr_b16 v[48:49], v7 offset:4096
    ds_read_b64_tr_b16 v[50:51], v7 offset:6144
    ds_read_b64_tr_b16 v[52:53], v8 offset:4096
    ds_read_b64_tr_b16 v[54:55], v8 offset:6144
    ds_read_b64_tr_b16 v[56:57], v9 offset:4096
    ds_read_b64_tr_b16 v[58:59], v9 offset:6144
    ds_read_b64_tr_b16 v[76:77], v6 offset:8192
    ds_read_b64_tr_b16 v[78:79], v6 offset:10240
    ds_read_b64_tr_b16 v[80:81], v7 offset:8192
    ds_read_b64_tr_b16 v[82:83], v7 offset:10240
    ds_read_b64_tr_b16 v[84:85], v8 offset:8192
    ds_read_b64_tr_b16 v[86:87], v8 offset:10240
    ds_read_b64_tr_b16 v[88:89], v9 offset:8192
    ds_read_b64_tr_b16 v[90:91], v9 offset:10240
    s_lshr_b32 s34, s66, 7
    s_lshl_b32 s45, 1, s34
WF_22:
    s_and_b32 s34, s44, s45
    s_cbranch_scc1 WFD_23
    s_cmp_eq_u32 s38, 0
    s_cbranch_scc1 WFP_24
    ds_read_b32 v27, v24
    s_waitcnt lgkmcnt(0)
    v_readfirstlane_b32 s44, v27
    s_branch WFC_25
WFP_24:
    buffer_load_dword v27, v12, s[16:19], s53 offen offset:0 sc1
    s_waitcnt vmcnt(0)
    v_cmp_eq_u32 vcc, v27, v26
    s_nop 3
    s_and_b32 s44, vcc_lo, 0xff
    v_mov_b32 v27, s44
    ds_write_b32 v24, v27
WFC_25:
    s_add_u32 s43, s43, 1
    s_cmp_ge_u32 s43, 1048576
    s_cbranch_scc0 WF_22
WFD_23:
    s_lshl_b32 s34, s66, 4
    s_add_u32 s34, s34, s50
    buffer_load_dwordx4 a[0:3], v10, s[16:19], s34 offen sc1
    buffer_load_dwordx4 a[4:7], v10, s[16:19], s34 offen offset:1024 sc1
    ds_read_b64_tr_b16 v[92:93], v6 offset:12288
    ds_read_b64_tr_b16 v[94:95], v6 offset:14336
    ds_read_b64_tr_b16 v[96:97], v7 offset:12288
    ds_read_b64_tr_b16 v[98:99], v7 offset:14336
    ds_read_b64_tr_b16 v[100:101], v8 offset:12288
    ds_read_b64_tr_b16 v[102:103], v8 offset:14336
    ds_read_b64_tr_b16 v[104:105], v9 offset:12288
    ds_read_b64_tr_b16 v[106:107], v9 offset:14336
    ds_read_b64_tr_b16 v[108:109], v6 offset:16384
    ds_read_b64_tr_b16 v[110:111], v6 offset:18432
    ds_read_b64_tr_b16 v[112:113], v7 offset:16384
    ds_read_b64_tr_b16 v[114:115], v7 offset:18432
    ds_read_b64_tr_b16 v[116:117], v8 offset:16384
    ds_read_b64_tr_b16 v[118:119], v8 offset:18432
    ds_read_b64_tr_b16 v[120:121], v9 offset:16384
    ds_read_b64_tr_b16 v[122:123], v9 offset:18432
    s_lshr_b32 s34, s67, 7
    s_lshl_b32 s45, 1, s34
WF_26:
    s_and_b32 s34, s44, s45
    s_cbranch_scc1 WFD_27
    s_cmp_eq_u32 s38, 0
    s_cbranch_scc1 WFP_28
    ds_read_b32 v27, v24
    s_waitcnt lgkmcnt(0)
    v_readfirstlane_b32 s44, v27
    s_branch WFC_29
WFP_28:
    buffer_load_dword v27, v12, s[16:19], s53 offen offset:0 sc1
    s_waitcnt vmcnt(0)
    v_cmp_eq_u32 vcc, v27, v26
    s_nop 3
    s_and_b32 s44, vcc_lo, 0xff
    v_mov_b32 v27, s44
    ds_write_b32 v24, v27
WFC_29:
    s_add_u32 s43, s43, 1
    s_cmp_ge_u32 s43, 1048576
    s_cbranch_scc0 WF_26
WFD_27:
    s_lshl_b32 s34, s67, 4
    s_add_u32 s34, s34, s50
    buffer_load_dwordx4 a[8:11], v10, s[16:19], s34 offen sc1
    buffer_load_dwordx4 a[12:15], v10, s[16:19], s34 offen offset:1024 sc1
    ds_read_b64_tr_b16 a[64:65], v6 offset:20480
    ds_read_b64_tr_b16 a[66:67], v6 offset:22528
    ds_read_b64_tr_b16 a[68:69], v7 offset:20480
    ds_read_b64_tr_b16 a[70:71], v7 offset:22528
    ds_read_b64_tr_b16 a[72:73], v8 offset:20480
    ds_read_b64_tr_b16 a[74:75], v8 offset:22528
    ds_read_b64_tr_b16 a[76:77], v9 offset:20480
    ds_read_b64_tr_b16 a[78:79], v9 offset:22528
    ds_read_b64_tr_b16 a[80:81], v6 offset:24576
    ds_read_b64_tr_b16 a[82:83], v6 offset:26624
    ds_read_b64_tr_b16 a[84:85], v7 offset:24576
    ds_read_b64_tr_b16 a[86:87], v7 offset:26624
    ds_read_b64_tr_b16 a[88:89], v8 offset:24576
    ds_read_b64_tr_b16 a[90:91], v8 offset:26624
    ds_read_b64_tr_b16 a[92:93], v9 offset:24576
    ds_read_b64_tr_b16 a[94:95], v9 offset:26624
    s_lshr_b32 s34, s68, 7
    s_lshl_b32 s45, 1, s34
WF_30:
    s_and_b32 s34, s44, s45
    s_cbranch_scc1 WFD_31
    s_cmp_eq_u32 s38, 0
    s_cbranch_scc1 WFP_32
    ds_read_b32 v27, v24
    s_waitcnt lgkmcnt(0)
    v_readfirstlane_b32 s44, v27
    s_branch WFC_33
WFP_32:
    buffer_load_dword v27, v12, s[16:19], s53 offen offset:0 sc1
    s_waitcnt vmcnt(0)
    v_cmp_eq_u32 vcc, v27, v26
    s_nop 3
    s_and_b32 s44, vcc_lo, 0xff
    v_mov_b32 v27, s44
    ds_write_b32 v24, v27
WFC_33:
    s_add_u32 s43, s43, 1
    s_cmp_ge_u32 s43, 1048576
    s_cbranch_scc0 WF_30
WFD_31:
    s_lshl_b32 s34, s68, 4
    s_add_u32 s34, s34, s50
    buffer_load_dwordx4 a[16:19], v10, s[16:19], s34 offen sc1
    buffer_load_dwordx4 a[20:23], v10, s[16:19], s34 offen offset:1024 sc1
    ds_read_b64_tr_b16 a[96:97], v6 offset:28672
    ds_read_b64_tr_b16 a[98:99], v6 offset:30720
    ds_read_b64_tr_b16 a[100:101], v7 offset:28672
    ds_read_b64_tr_b16 a[102:103], v7 offset:30720
    ds_read_b64_tr_b16 a[104:105], v8 offset:28672
    ds_read_b64_tr_b16 a[106:107], v8 offset:30720
    ds_read_b64_tr_b16 a[108:109], v9 offset:28672
    ds_read_b64_tr_b16 a[110:111], v9 offset:30720
    s_waitcnt vmcnt(4) lgkmcnt(0)
    v_mfma_f32_16x16x32_bf16 v[60:63], v[28:31], a[0:3], 0
    ds_read_b64_tr_b16 a[112:113], v6 offset:32768
    ds_read_b64_tr_b16 a[114:115], v6 offset:34816
    v_mfma_f32_16x16x32_bf16 v[64:67], v[32:35], a[0:3], 0
    ds_read_b64_tr_b16 a[116:117], v7 offset:32768
    ds_read_b64_tr_b16 a[118:119], v7 offset:34816
    v_mfma_f32_16x16x32_bf16 v[68:71], v[36:39], a[0:3], 0
    ds_read_b64_tr_b16 a[120:121], v8 offset:32768
    ds_read_b64_tr_b16 a[122:123], v8 offset:34816
    v_mfma_f32_16x16x32_bf16 v[72:75], v[40:43], a[0:3], 0
    ds_read_b64_tr_b16 a[124:125], v9 offset:32768
    ds_read_b64_tr_b16 a[126:127], v9 offset:34816
    v_mfma_f32_16x16x32_bf16 v[60:63], v[44:47], a[4:7], v[60:63]
    ds_read_b64_tr_b16 v[28:29], v6 offset:36864
    ds_read_b64_tr_b16 v[30:31], v6 offset:38912
    v_mfma_f32_16x16x32_bf16 v[64:67], v[48:51], a[4:7], v[64:67]
    ds_read_b64_tr_b16 v[32:33], v7 offset:36864
    ds_read_b64_tr_b16 v[34:35], v7 offset:38912
    v_mfma_f32_16x16x32_bf16 v[68:71], v[52:55], a[4:7], v[68:71]
    ds_read_b64_tr_b16 v[36:37], v8 offset:36864
    ds_read_b64_tr_b16 v[38:39], v8 offset:38912
    v_mfma_f32_16x16x32_bf16 v[72:75], v[56:59], a[4:7], v[72:75]
    ds_read_b64_tr_b16 v[40:41], v9 offset:36864
    ds_read_b64_tr_b16 v[42:43], v9 offset:38912
    s_lshr_b32 s34, s69, 7
    s_lshl_b32 s45, 1, s34
WF_34:
    s_and_b32 s34, s44, s45
    s_cbranch_scc1 WFD_35
    s_cmp_eq_u32 s38, 0
    s_cbranch_scc1 WFP_36
    ds_read_b32 v27, v24
    s_waitcnt lgkmcnt(0)
    v_readfirstlane_b32 s44, v27
    s_branch WFC_37
WFP_36:
    buffer_load_dword v27, v12, s[16:19], s53 offen offset:0 sc1
    s_waitcnt vmcnt(0)
    v_cmp_eq_u32 vcc, v27, v26
    s_nop 3
    s_and_b32 s44, vcc_lo, 0xff
    v_mov_b32 v27, s44
    ds_write_b32 v24, v27
WFC_37:
    s_add_u32 s43, s43, 1
    s_cmp_ge_u32 s43, 1048576
    s_cbranch_scc0 WF_34
WFD_35:
    s_lshl_b32 s34, s69, 4
    s_add_u32 s34, s34, s50
    buffer_load_dwordx4 a[24:27], v10, s[16:19], s34 offen sc1
    buffer_load_dwordx4 a[28:31], v10, s[16:19], s34 offen offset:1024 sc1
    s_waitcnt vmcnt(4) lgkmcnt(0)
    v_mfma_f32_16x16x32_bf16 v[60:63], v[76:79], a[8:11], v[60:63]
    ds_read_b64_tr_b16 v[44:45], v6 offset:40960
    ds_read_b64_tr_b16 v[46:47], v6 offset:43008
    v_mfma_f32_16x16x32_bf16 v[64:67], v[80:83], a[8:11], v[64:67]
    ds_read_b64_tr_b16 v[48:49], v7 offset:40960
    ds_read_b64_tr_b16 v[50:51], v7 offset:43008
    v_mfma_f32_16x16x32_bf16 v[68:71], v[84:87], a[8:11], v[68:71]
    ds_read_b64_tr_b16 v[52:53], v8 offset:40960
    ds_read_b64_tr_b16 v[54:55], v8 offset:43008
    v_mfma_f32_16x16x32_bf16 v[72:75], v[88:91], a[8:11], v[72:75]
    ds_read_b64_tr_b16 v[56:57], v9 offset:40960
    ds_read_b64_tr_b16 v[58:59], v9 offset:43008
    v_mfma_f32_16x16x32_bf16 v[60:63], v[92:95], a[12:15], v[60:63]
    ds_read_b64_tr_b16 v[76:77], v6 offset:45056
    ds_read_b64_tr_b16 v[78:79], v6 offset:47104
    v_mfma_f32_16x16x32_bf16 v[64:67], v[96:99], a[12:15], v[64:67]
    ds_read_b64_tr_b16 v[80:81], v7 offset:45056
    ds_read_b64_tr_b16 v[82:83], v7 offset:47104
    v_mfma_f32_16x16x32_bf16 v[68:71], v[100:103], a[12:15], v[68:71]
    ds_read_b64_tr_b16 v[84:85], v8 offset:45056
    ds_read_b64_tr_b16 v[86:87], v8 offset:47104
    v_mfma_f32_16x16x32_bf16 v[72:75], v[104:107], a[12:15], v[72:75]
    ds_read_b64_tr_b16 v[88:89], v9 offset:45056
    ds_read_b64_tr_b16 v[90:91], v9 offset:47104
    s_lshr_b32 s34, s70, 7
    s_lshl_b32 s45, 1, s34
WF_38:
    s_and_b32 s34, s44, s45
    s_cbranch_scc1 WFD_39
    s_cmp_eq_u32 s38, 0
    s_cbranch_scc1 WFP_40
    ds_read_b32 v27, v24
    s_waitcnt lgkmcnt(0)
    v_readfirstlane_b32 s44, v27
    s_branch WFC_41
WFP_40:
    buffer_load_dword v27, v12, s[16:19], s53 offen offset:0 sc1
    s_waitcnt vmcnt(0)
    v_cmp_eq_u32 vcc, v27, v26
    s_nop 3
    s_and_b32 s44, vcc_lo, 0xff
    v_mov_b32 v27, s44
    ds_write_b32 v24, v27
WFC_41:
    s_add_u32 s43, s43, 1
    s_cmp_ge_u32 s43, 1048576
    s_cbranch_scc0 WF_38
WFD_39:
    s_lshl_b32 s34, s70, 4
    s_add_u32 s34, s34, s50
    buffer_load_dwordx4 a[32:35], v10, s[16:19], s34 offen sc1
    buffer_load_dwordx4 a[36:39], v10, s[16:19], s34 offen offset:1024 sc1
    s_waitcnt vmcnt(4) lgkmcnt(0)
    v_mfma_f32_16x16x32_bf16 v[60:63], v[108:111], a[16:19], v[60:63]
    ds_read_b64_tr_b16 v[92:93], v6 offset:49152
    ds_read_b64_tr_b16 v[94:95], v6 offset:51200
    v_mfma_f32_16x16x32_bf16 v[64:67], v[112:115], a[16:19], v[64:67]
    ds_read_b64_tr_b16 v[96:97], v7 offset:49152
    ds_read_b64_tr_b16 v[98:99], v7 offset:51200
    v_mfma_f32_16x16x32_bf16 v[68:71], v[116:119], a[16:19], v[68:71]
    ds_read_b64_tr_b16 v[100:101], v8 offset:49152
    ds_read_b64_tr_b16 v[102:103], v8 offset:51200
    v_mfma_f32_16x16x32_bf16 v[72:75], v[120:123], a[16:19], v[72:75]
    ds_read_b64_tr_b16 v[104:105], v9 offset:49152
    ds_read_b64_tr_b16 v[106:107], v9 offset:51200
    v_mfma_f32_16x16x32_bf16 v[60:63], a[64:67], a[20:23], v[60:63]
    ds_read_b64_tr_b16 v[108:109], v6 offset:53248
    ds_read_b64_tr_b16 v[110:111], v6 offset:55296
    v_mfma_f32_16x16x32_bf16 v[64:67], a[68:71], a[20:23], v[64:67]
    ds_read_b64_tr_b16 v[112:113], v7 offset:53248
    ds_read_b64_tr_b16 v[114:115], v7 offset:55296
    v_mfma_f32_16x16x32_bf16 v[68:71], a[72:75], a[20:23], v[68:71]
    ds_read_b64_tr_b16 v[116:117], v8 offset:53248
    ds_read_b64_tr_b16 v[118:119], v8 offset:55296
    v_mfma_f32_16x16x32_bf16 v[72:75], a[76:79], a[20:23], v[72:75]
    ds_read_b64_tr_b16 v[120:121], v9 offset:53248
    ds_read_b64_tr_b16 v[122:123], v9 offset:55296
    s_lshr_b32 s34, s71, 7
    s_lshl_b32 s45, 1, s34
WF_42:
    s_and_b32 s34, s44, s45
    s_cbranch_scc1 WFD_43
    s_cmp_eq_u32 s38, 0
    s_cbranch_scc1 WFP_44
    ds_read_b32 v27, v24
    s_waitcnt lgkmcnt(0)
    v_readfirstlane_b32 s44, v27
    s_branch WFC_45
WFP_44:
    buffer_load_dword v27, v12, s[16:19], s53 offen offset:0 sc1
    s_waitcnt vmcnt(0)
    v_cmp_eq_u32 vcc, v27, v26
    s_nop 3
    s_and_b32 s44, vcc_lo, 0xff
    v_mov_b32 v27, s44
    ds_write_b32 v24, v27
WFC_45:
    s_add_u32 s43, s43, 1
    s_cmp_ge_u32 s43, 1048576
    s_cbranch_scc0 WF_42
WFD_43:
    s_lshl_b32 s34, s71, 4
    s_add_u32 s34, s34, s50
    buffer_load_dwordx4 a[40:43], v10, s[16:19], s34 offen sc1
    buffer_load_dwordx4 a[44:47], v10, s[16:19], s34 offen offset:1024 sc1
    s_waitcnt vmcnt(4) lgkmcnt(0)
    v_mfma_f32_16x16x32_bf16 v[60:63], a[80:83], a[24:27], v[60:63]
    ds_read_b64_tr_b16 a[64:65], v6 offset:57344
    ds_read_b64_tr_b16 a[66:67], v6 offset:59392
    v_mfma_f32_16x16x32_bf16 v[64:67], a[84:87], a[24:27], v[64:67]
    ds_read_b64_tr_b16 a[68:69], v7 offset:57344
    ds_read_b64_tr_b16 a[70:71], v7 offset:59392
    v_mfma_f32_16x16x32_bf16 v[68:71], a[88:91], a[24:27], v[68:71]
    ds_read_b64_tr_b16 a[72:73], v8 offset:57344
    ds_read_b64_tr_b16 a[74:75], v8 offset:59392
    v_mfma_f32_16x16x32_bf16 v[72:75], a[92:95], a[24:27], v[72:75]
    ds_read_b64_tr_b16 a[76:77], v9 offset:57344
    ds_read_b64_tr_b16 a[78:79], v9 offset:59392
    v_mfma_f32_16x16x32_bf16 v[60:63], a[96:99], a[28:31], v[60:63]
    ds_read_b64_tr_b16 a[80:81], v6 offset:61440
    ds_read_b64_tr_b16 a[82:83], v6 offset:63488
    v_mfma_f32_16x16x32_bf16 v[64:67], a[100:103], a[28:31], v[64:67]
    ds_read_b64_tr_b16 a[84:85], v7 offset:61440
    ds_read_b64_tr_b16 a[86:87], v7 offset:63488
    v_mfma_f32_16x16x32_bf16 v[68:71], a[104:107], a[28:31], v[68:71]
    ds_read_b64_tr_b16 a[88:89], v8 offset:61440
    ds_read_b64_tr_b16 a[90:91], v8 offset:63488
    v_mfma_f32_16x16x32_bf16 v[72:75], a[108:111], a[28:31], v[72:75]
    ds_read_b64_tr_b16 a[92:93], v9 offset:61440
    ds_read_b64_tr_b16 a[94:95], v9 offset:63488
    s_lshr_b32 s34, s72, 7
    s_lshl_b32 s45, 1, s34
WF_46:
    s_and_b32 s34, s44, s45
    s_cbranch_scc1 WFD_47
    s_cmp_eq_u32 s38, 0
    s_cbranch_scc1 WFP_48
    ds_read_b32 v27, v24
    s_waitcnt lgkmcnt(0)
    v_readfirstlane_b32 s44, v27
    s_branch WFC_49
WFP_48:
    buffer_load_dword v27, v12, s[16:19], s53 offen offset:0 sc1
    s_waitcnt vmcnt(0)
    v_cmp_eq_u32 vcc, v27, v26
    s_nop 3
    s_and_b32 s44, vcc_lo, 0xff
    v_mov_b32 v27, s44
    ds_write_b32 v24, v27
WFC_49:
    s_add_u32 s43, s43, 1
    s_cmp_ge_u32 s43, 1048576
    s_cbranch_scc0 WF_46
WFD_47:
    s_lshl_b32 s34, s72, 4
    s_add_u32 s34, s34, s50
    buffer_load_dwordx4 a[48:51], v10, s[16:19], s34 offen sc1
    buffer_load_dwordx4 a[52:55], v10, s[16:19], s34 offen offset:1024 sc1
    s_waitcnt vmcnt(4) lgkmcnt(0)
    v_mfma_f32_16x16x32_bf16 v[60:63], a[112:115], a[32:35], v[60:63]
    v_mfma_f32_16x16x32_bf16 v[64:67], a[116:119], a[32:35], v[64:67]
    v_mfma_f32_16x16x32_bf16 v[68:71], a[120:123], a[32:35], v[68:71]
    v_mfma_f32_16x16x32_bf16 v[72:75], a[124:127], a[32:35], v[72:75]
    v_mfma_f32_16x16x32_bf16 v[60:63], v[28:31], a[36:39], v[60:63]
    v_mfma_f32_16x16x32_bf16 v[64:67], v[32:35], a[36:39], v[64:67]
    v_mfma_f32_16x16x32_bf16 v[68:71], v[36:39], a[36:39], v[68:71]
    v_mfma_f32_16x16x32_bf16 v[72:75], v[40:43], a[36:39], v[72:75]
    s_lshr_b32 s34, s73, 7
    s_lshl_b32 s45, 1, s34
WF_50:
    s_and_b32 s34, s44, s45
    s_cbranch_scc1 WFD_51
    s_cmp_eq_u32 s38, 0
    s_cbranch_scc1 WFP_52
    ds_read_b32 v27, v24
    s_waitcnt lgkmcnt(0)
    v_readfirstlane_b32 s44, v27
    s_branch WFC_53
WFP_52:
    buffer_load_dword v27, v12, s[16:19], s53 offen offset:0 sc1
    s_waitcnt vmcnt(0)
    v_cmp_eq_u32 vcc, v27, v26
    s_nop 3
    s_and_b32 s44, vcc_lo, 0xff
    v_mov_b32 v27, s44
    ds_write_b32 v24, v27
WFC_53:
    s_add_u32 s43, s43, 1
    s_cmp_ge_u32 s43, 1048576
    s_cbranch_scc0 WF_50
WFD_51:
    s_lshl_b32 s34, s73, 4
    s_add_u32 s34, s34, s50
    buffer_load_dwordx4 a[56:59], v10, s[16:19], s34 offen sc1
    buffer_load_dwordx4 a[60:63], v10, s[16:19], s34 offen offset:1024 sc1
    buffer_load_dwordx2 v[14:15], v13, s[16:19], s46 offen sc1
    s_waitcnt vmcnt(5) lgkmcnt(0)
    v_mfma_f32_16x16x32_bf16 v[60:63], v[44:47], a[40:43], v[60:63]
    v_mfma_f32_16x16x32_bf16 v[64:67], v[48:51], a[40:43], v[64:67]
    v_mfma_f32_16x16x32_bf16 v[68:71], v[52:55], a[40:43], v[68:71]
    v_mfma_f32_16x16x32_bf16 v[72:75], v[56:59], a[40:43], v[72:75]
    v_mfma_f32_16x16x32_bf16 v[60:63], v[76:79], a[44:47], v[60:63]
    v_mfma_f32_16x16x32_bf16 v[64:67], v[80:83], a[44:47], v[64:67]
    v_mfma_f32_16x16x32_bf16 v[68:71], v[84:87], a[44:47], v[68:71]
    v_mfma_f32_16x16x32_bf16 v[72:75], v[88:91], a[44:47], v[72:75]
    s_waitcnt vmcnt(3) lgkmcnt(0)
    v_mfma_f32_16x16x32_bf16 v[60:63], v[92:95], a[48:51], v[60:63]
    v_mfma_f32_16x16x32_bf16 v[64:67], v[96:99], a[48:51], v[64:67]
    v_mfma_f32_16x16x32_bf16 v[68:71], v[100:103], a[48:51], v[68:71]
    v_mfma_f32_16x16x32_bf16 v[72:75], v[104:107], a[48:51], v[72:75]
    v_mfma_f32_16x16x32_bf16 v[60:63], v[108:111], a[52:55], v[60:63]
    v_mfma_f32_16x16x32_bf16 v[64:67], v[112:115], a[52:55], v[64:67]
    v_mfma_f32_16x16x32_bf16 v[68:71], v[116:119], a[52:55], v[68:71]
    v_mfma_f32_16x16x32_bf16 v[72:75], v[120:123], a[52:55], v[72:75]
    s_waitcnt vmcnt(1) lgkmcnt(0)
    v_mfma_f32_16x16x32_bf16 v[60:63], a[64:67], a[56:59], v[60:63]
    v_mfma_f32_16x16x32_bf16 v[64:67], a[68:71], a[56:59], v[64:67]
    v_mfma_f32_16x16x32_bf16 v[68:71], a[72:75], a[56:59], v[68:71]
    v_mfma_f32_16x16x32_bf16 v[72:75], a[76:79], a[56:59], v[72:75]
    v_mfma_f32_16x16x32_bf16 v[60:63], a[80:83], a[60:63], v[60:63]
    v_mfma_f32_16x16x32_bf16 v[64:67], a[84:87], a[60:63], v[64:67]
    v_mfma_f32_16x16x32_bf16 v[68:71], a[88:91], a[60:63], v[68:71]
    v_mfma_f32_16x16x32_bf16 v[72:75], a[92:95], a[60:63], v[72:75]
    s_lshl_b32 s34, s38, 12
    s_add_u32 s34, s34, 140288
    v_lshl_add_u32 v24, v1, 4, s34
    v_and_b32 v25, 15, v1
    v_lshlrev_b32 v25, 10, v25
    v_lshrrev_b32 v26, 4, v1
    v_lshl_add_u32 v25, v26, 3, v25
    s_lshl_b32 s34, s55, 7
    s_lshl_b32 s35, s51, 8
    s_add_u32 s36, s34, s35
    v_mov_b32 v26, s40
    s_mov_b32 s43, 0
    s_waitcnt vmcnt(0)
GP_54:
    v_cmp_ne_u32 vcc, v15, v26
    s_nop 3
    s_cbranch_vccz GOK_55
    s_add_u32 s43, s43, 1
    s_cmp_ge_u32 s43, 131072
    s_cbranch_scc1 GOK_55
    buffer_load_dwordx2 v[14:15], v13, s[16:19], s46 offen sc1
    s_waitcnt vmcnt(0)
    s_branch GP_54
GOK_55:
    s_cmp_eq_u32 s39, 1
    s_cbranch_scc1 FIN_B_56
    v_mul_f32 v68, v68, v14
    v_mul_f32 v69, v69, v14
    v_mul_f32 v70, v70, v14
    v_mul_f32 v71, v71, v14
    ds_write_b128 v24, v[68:71] offset:2048
    v_mul_f32 v72, v72, v14
    v_mul_f32 v73, v73, v14
    v_mul_f32 v74, v74, v14
    v_mul_f32 v75, v75, v14
    ds_write_b128 v24, v[72:75] offset:3072
    v_mul_f32 v60, v60, v14
    v_mul_f32 v61, v61, v14
    v_mul_f32 v62, v62, v14
    v_mul_f32 v63, v63, v14
    v_mul_f32 v64, v64, v14
    v_mul_f32 v65, v65, v14
    v_mul_f32 v66, v66, v14
    v_mul_f32 v67, v67, v14
    s_waitcnt lgkmcnt(0)
    s_barrier
    ds_read_b128 v[28:31], v24 offset:0
    ds_read_b128 v[32:35], v24 offset:1024
    s_waitcnt lgkmcnt(1)
    v_add_f32 v60, v60, v28
    v_add_f32 v61, v61, v29
    v_add_f32 v62, v62, v30
    v_add_f32 v63, v63, v31
    v_cvt_pk_bf16_f32 v44, v60, v61
    v_cvt_pk_bf16_f32 v45, v62, v63
    buffer_store_dwordx2 v[44:45], v25, s[60:63], s36 offen offset:0
    s_waitcnt lgkmcnt(0)
    v_add_f32 v64, v64, v32
    v_add_f32 v65, v65, v33
    v_add_f32 v66, v66, v34
    v_add_f32 v67, v67, v35
    v_cvt_pk_bf16_f32 v46, v64, v65
    v_cvt_pk_bf16_f32 v47, v66, v67
    buffer_store_dwordx2 v[46:47], v25, s[60:63], s36 offen offset:32
    s_endpgm
FIN_B_56:
    v_sub_f32 v14, 1.0, v14
    v_mul_f32 v60, v60, v14
    v_mul_f32 v61, v61, v14
    v_mul_f32 v62, v62, v14
    v_mul_f32 v63, v63, v14
    ds_write_b128 v24, v[60:63] offset:0
    v_mul_f32 v64, v64, v14
    v_mul_f32 v65, v65, v14
    v_mul_f32 v66, v66, v14
    v_mul_f32 v67, v67, v14
    ds_write_b128 v24, v[64:67] offset:1024
    v_mul_f32 v68, v68, v14
    v_mul_f32 v69, v69, v14
    v_mul_f32 v70, v70, v14
    v_mul_f32 v71, v71, v14
    v_mul_f32 v72, v72, v14
    v_mul_f32 v73, v73, v14
    v_mul_f32 v74, v74, v14
    v_mul_f32 v75, v75, v14
    s_waitcnt lgkmcnt(0)
    s_barrier
    ds_read_b128 v[28:31], v24 offset:2048
    ds_read_b128 v[32:35], v24 offset:3072
    s_waitcnt lgkmcnt(1)
    v_add_f32 v68, v68, v28
    v_add_f32 v69, v69, v29
    v_add_f32 v70, v70, v30
    v_add_f32 v71, v71, v31
    v_cvt_pk_bf16_f32 v44, v68, v69
    v_cvt_pk_bf16_f32 v45, v70, v71
    buffer_store_dwordx2 v[44:45], v25, s[60:63], s36 offen offset:64
    s_waitcnt lgkmcnt(0)
    v_add_f32 v72, v72, v32
    v_add_f32 v73, v73, v33
    v_add_f32 v74, v74, v34
    v_add_f32 v75, v75, v35
    v_cvt_pk_bf16_f32 v46, v72, v73
    v_cvt_pk_bf16_f32 v47, v74, v75
    buffer_store_dwordx2 v[46:47], v25, s[60:63], s36 offen offset:96
L_END:
    s_endpgm
.section .rodata,"a"
.p2align 6
.amdhsa_kernel gated_mix__linear_attn_block__sliding_local_dilated__prompt_kernel
  .amdhsa_next_free_vgpr 256
  .amdhsa_next_free_sgpr 96
  .amdhsa_accum_offset 128
  .amdhsa_group_segment_fixed_size 0
  .amdhsa_kernarg_size 80
  .amdhsa_user_sgpr_count 2
  .amdhsa_user_sgpr_kernarg_segment_ptr 1
  .amdhsa_system_sgpr_workgroup_id_x 1
  .amdhsa_float_denorm_mode_32 3
.end_amdhsa_kernel
```
